```python
import torch

def _softmax(x, axis=-1):
    return torch.softmax(x, dim=axis)
def _gelu(x):
    return torch.nn.functional.gelu(x, approximate="tanh")
def _silu(x):
    return torch.nn.functional.silu(x)
def _sigmoid(x):
    return torch.sigmoid(x)
def _layernorm(x, axis=-1, eps=1e-5):
    m = x.mean(dim=axis, keepdim=True)
    v = x.var(dim=axis, keepdim=True, unbiased=False)
    return (x - m) / torch.sqrt(v + eps)
def _scatter_add(tgt, idx, src, axis=0):
    return tgt.clone().index_add_(axis, idx, src)
def _segment_sum(src, seg, n):
    out = torch.zeros((n,) + src.shape[1:], dtype=src.dtype)
    return out.index_add_(0, seg, src)
def _pad(x, pw):
    flat = tuple(v for pair in reversed(pw) for v in pair)
    return torch.nn.functional.pad(x, flat)

kernel_name = 'standalone__mixer_channel_mlp__prompt'

def setup_inputs():

    _w = (lambda a: (lambda t: t.to(torch.bfloat16) if t.is_floating_point() else t)(torch.as_tensor(a)))
    B, S, D, F = 1, 2048, 640, 1536
    return {
        "x": _w((lambda *s: torch.randn(*s, dtype=torch.bfloat16) * 0.05)(B, S, D)),
        "w1": _w((lambda *s: torch.randn(*s, dtype=torch.bfloat16) * 0.8)(D, F) * (D ** -0.5)),
        "b1": _w((lambda *s: torch.randn(*s, dtype=torch.bfloat16) * 0.4)(F)),
        "w2": _w((lambda *s: torch.randn(*s, dtype=torch.bfloat16) * 0.05)(F, D) * (F ** -0.5)),
        "b2": _w((lambda *s: torch.randn(*s, dtype=torch.bfloat16) * 0.05)(D)),
    }

def reference(x, w1, b1, w2, b2):
    y = _layernorm(x, axis=-1)
    h = _gelu(torch.einsum("bsd,df->bsf", y, w1) + b1)
    return torch.einsum("bsf,fd->bsd", h, w2) + b2
```

```asm
; @launch grid=(256,1,1) block=(256,1,1) lds=131072
.amdgcn_target "amdgcn-amd-amdhsa--gfx950"
.set NPF, (L_codeend - standalone__mixer_channel_mlp__prompt_kernel + 1023) / 1024
.text
.globl standalone__mixer_channel_mlp__prompt_kernel
.p2align 8
.type standalone__mixer_channel_mlp__prompt_kernel,@function
standalone__mixer_channel_mlp__prompt_kernel:
  s_load_dwordx8 s[8:15], s[0:1], 0
  s_load_dwordx8 s[16:23], s[0:1], 32
  s_cmp_ge_u32 s2, 256
  s_cbranch_scc1 L_end
  v_lshrrev_b32 v16, 6, v0
  v_and_b32 v0, 63, v0
  v_readfirstlane_b32 s5, v16
  v_lshlrev_b32 v1, 4, v0
  s_lshr_b32 s53, s2, 3
  s_getpc_b64 s[58:59]
  s_lshl_b32 s54, s53, 2
  s_add_u32 s54, s54, s5
  s_and_b32 s54, s54, 31
  s_min_u32 s54, s54, NPF-1
  s_lshl_b32 s54, s54, 10
  v_add_u32 v2, s54, v1
  global_load_dwordx4 a[252:255], v2, s[58:59]
  s_and_b32 s54, s2, 7
  s_lshr_b32 s3, s54, 1
  s_lshl_b32 s3, s3, 2
  s_and_b32 s55, s53, 3
  s_add_u32 s3, s3, s55
  s_and_b32 s54, s54, 1
  s_lshr_b32 s55, s53, 2
  s_lshl_b32 s4, s54, 3
  s_add_u32 s4, s4, s55
  s_mov_b32 s6, s54
  s_mov_b32 s7, s55
  v_lshrrev_b32 v204, 4, v0
  v_and_b32 v205, 15, v0
  s_lshl_b32 s53, s3, 7
  s_lshl_b32 s54, s5, 5
  s_add_u32 s53, s53, s54
  v_lshrrev_b32 v206, 3, v0
  v_add_u32 v206, s53, v206
  v_mul_u32_u24 v206, 1280, v206
  v_and_b32 v207, 7, v0
  v_xor_b32 v207, v207, v204
  v_lshl_add_u32 v2, v207, 4, v206
  v_xor_b32 v207, 4, v207
  v_lshl_add_u32 v3, v207, 4, v206
  v_add_u32 v3, 9216, v3
  v_add_u32 v254, 18432, v2
  v_add_u32 v255, 18432, v3
  v_add_u32 v206, 0, v0
  v_mul_u32_u24 v207, 171, v206
  v_lshrrev_b32 v207, 11, v207
  v_mul_u32_u24 v208, 12, v207
  v_sub_u32 v208, v206, v208
  v_lshrrev_b32 v209, 2, v207
  v_and_b32 v209, 2, v209
  v_xor_b32 v208, v208, v209
  v_mul_u32_u24 v207, 3072, v207
  v_lshl_add_u32 v4, v208, 4, v207
  v_add_u32 v206, 64, v0
  v_mul_u32_u24 v207, 171, v206
  v_lshrrev_b32 v207, 11, v207
  v_mul_u32_u24 v208, 12, v207
  v_sub_u32 v208, v206, v208
  v_lshrrev_b32 v209, 2, v207
  v_and_b32 v209, 2, v209
  v_xor_b32 v208, v208, v209
  v_mul_u32_u24 v207, 3072, v207
  v_lshl_add_u32 v5, v208, 4, v207
  v_subrev_u32 v5, 1024, v5
  v_add_u32 v206, 128, v0
  v_mul_u32_u24 v207, 171, v206
  v_lshrrev_b32 v207, 11, v207
  v_mul_u32_u24 v208, 12, v207
  v_sub_u32 v208, v206, v208
  v_lshrrev_b32 v209, 2, v207
  v_and_b32 v209, 2, v209
  v_xor_b32 v208, v208, v209
  v_mul_u32_u24 v207, 3072, v207
  v_lshl_add_u32 v6, v208, 4, v207
  v_subrev_u32 v6, 2048, v6
  s_mul_i32 s54, s4, 192
  s_mul_i32 s55, s5, 49152
  s_add_u32 s52, s54, s55
  s_add_u32 s48, s4, s3
  s_and_b32 s48, s48, 1
  s_mul_i32 s54, s48, 983040
  s_add_u32 s52, s52, s54
  s_mul_i32 s48, s48, 640
  s_lshl_b32 s56, s5, 12
  s_mul_i32 s57, s5, 3072
  s_add_u32 s57, s57, 16384
  s_lshl_b32 s54, s3, 7
  s_lshl_b32 s55, s4, 3
  s_add_u32 s54, s54, s55
  s_lshl_b32 s55, s5, 1
  s_add_u32 s54, s54, s55
  v_lshrrev_b32 v206, 5, v0
  v_add_u32 v16, s54, v206
  v_mul_u32_u24 v15, 1280, v16
  v_and_b32 v207, 31, v0
  v_lshl_add_u32 v15, v207, 3, v15
  s_waitcnt lgkmcnt(0)
  s_mov_b32 s24, s8
  s_and_b32 s25, s9, 0xffff
  s_mov_b32 s26, 2621440
  s_mov_b32 s27, 0x20000
  buffer_load_dwordx2 v[206:207], v15, s[24:27], 0 offen offset:0
  buffer_load_dwordx2 v[208:209], v15, s[24:27], 0 offen offset:256
  buffer_load_dwordx2 v[210:211], v15, s[24:27], 0 offen offset:512
  buffer_load_dwordx2 v[212:213], v15, s[24:27], 0 offen offset:768
  buffer_load_dwordx2 v[214:215], v15, s[24:27], 0 offen offset:1024
  s_mov_b32 s28, s10
  s_and_b32 s29, s11, 0xffff
  s_mov_b32 s30, 1966080
  s_mov_b32 s31, 0x20000
  s_mov_b32 s20, 0
  s_add_u32 m0, s56, 0
  s_add_u32 s49, s48, 0
  buffer_load_dwordx4 v2, s[24:27], s49 offen lds
  buffer_load_dwordx4 v3, s[24:27], s49 offen offset:1024 lds
  buffer_load_dwordx4 v254, s[24:27], s49 offen offset:2048 lds
  buffer_load_dwordx4 v255, s[24:27], s49 offen offset:3072 lds
  s_add_u32 m0, s57, 0
  s_nop 0
  buffer_load_dwordx4 v4, s[28:31], s52 offen lds
  buffer_load_dwordx4 v5, s[28:31], s52 offen offset:1024 lds
  buffer_load_dwordx4 v6, s[28:31], s52 offen offset:2048 lds
  s_add_u32 s60, s22, 8519680
  s_addc_u32 s61, s23, 0
  s_load_dwordx2 s[44:45], s[60:61], 0
  s_mov_b32 s32, s14
  s_and_b32 s33, s15, 0xffff
  s_mov_b32 s34, 1966080
  s_mov_b32 s35, 0x20000
  v_mul_u32_u24 v17, 1280, v204
  v_lshl_add_u32 v17, v205, 4, v17
  s_sub_u32 s55, s2, 240
  s_cmp_ge_u32 s2, 240
  s_cselect_b32 s55, s55, s2
  s_mul_i32 s62, s55, 205
  s_lshr_b32 s62, s62, 10
  s_mul_i32 s63, s62, 5
  s_sub_u32 s63, s55, s63
  s_lshl_b32 s54, s62, 5
  s_lshl_b32 s55, s5, 3
  s_add_u32 s54, s54, s55
  s_mul_i32 s54, s54, 1280
  s_lshl_b32 s55, s63, 8
  s_add_u32 s54, s54, s55
  s_add_u32 s55, s54, 4096
  s_lshl_b32 m0, s5, 11
  s_add_u32 m0, m0, 114688
  s_nop 0
  buffer_load_dwordx4 v17, s[32:35], s54 offen lds
  buffer_load_dwordx4 v17, s[32:35], s55 offen offset:1024 lds
  s_add_u32 m0, s56, 28672
  s_add_u32 s49, s48, 128
  buffer_load_dwordx4 v2, s[24:27], s49 offen lds
  buffer_load_dwordx4 v3, s[24:27], s49 offen offset:1024 lds
  buffer_load_dwordx4 v254, s[24:27], s49 offen offset:2048 lds
  buffer_load_dwordx4 v255, s[24:27], s49 offen offset:3072 lds
  s_add_u32 m0, s57, 28672
  s_add_u32 s52, s52, 196608
  buffer_load_dwordx4 v4, s[28:31], s52 offen lds
  buffer_load_dwordx4 v5, s[28:31], s52 offen offset:1024 lds
  buffer_load_dwordx4 v6, s[28:31], s52 offen offset:2048 lds
  s_mov_b32 s36, s22
  s_and_b32 s37, s23, 0xffff
  s_mov_b32 s38, 33554432
  s_mov_b32 s39, 0x20000
  s_mov_b32 s40, s18
  s_and_b32 s41, s19, 0xffff
  s_mov_b32 s42, 2621440
  s_mov_b32 s43, 0x20000
  s_sub_u32 s23, 640, s48
  s_cmp_eq_u32 s48, 0
  s_mov_b32 s22, 196608
  s_cselect_b32 s22, s22, 4293197824
  v_lshrrev_b32 v216, 1, v205
  v_xor_b32 v216, v216, v204
  v_lshlrev_b32 v216, 4, v216
  v_lshl_add_u32 v216, v205, 7, v216
  v_add_u32 v7, s56, v216
  v_xor_b32 v9, 64, v7
  v_add_u32 v8, 57344, v7
  v_add_u32 v10, 57344, v9
  v_lshrrev_b32 v216, 2, v205
  v_lshl_add_u32 v216, v204, 3, v216
  v_mul_u32_u24 v216, 192, v216
  v_and_b32 v217, 3, v205
  v_lshl_add_u32 v216, v217, 3, v216
  v_and_b32 v217, 1, v204
  v_lshl_add_u32 v216, v217, 5, v216
  v_add_u32 v11, 16384, v216
  v_xor_b32 v13, 32, v11
  v_add_u32 v12, 57344, v11
  v_add_u32 v14, 57344, v13
  v_lshrrev_b32 v216, 2, v205
  v_lshl_add_u32 v216, v204, 2, v216
  v_lshlrev_b32 v216, 8, v216
  v_and_b32 v217, 3, v205
  v_lshl_add_u32 v216, v217, 3, v216
  s_lshl_b32 s54, s5, 6
  s_add_u32 s54, s54, 114688
  v_add_u32 v17, s54, v216
  v_add_u32 v18, s53, v205
  v_lshlrev_b32 v18, 4, v18
  v_add_u32 v18, 8388608, v18
  v_mov_b32 v20, 0x3f803f80
  v_mov_b32 v21, 0x3f803f80
  v_mov_b32 v22, 0x3f803f80
  v_mov_b32 v23, 0x3f803f80
  s_mul_i32 s54, s4, 192
  v_lshlrev_b32 v216, 3, v204
  v_add_u32 v216, s54, v216
  global_load_dwordx2 v[24:25], v216, s[12:13] offset:0
  global_load_dwordx2 v[26:27], v216, s[12:13] offset:32
  global_load_dwordx2 v[28:29], v216, s[12:13] offset:64
  global_load_dwordx2 v[30:31], v216, s[12:13] offset:96
  global_load_dwordx2 v[32:33], v216, s[12:13] offset:128
  global_load_dwordx2 v[34:35], v216, s[12:13] offset:160
  v_lshlrev_b32 v246, 4, v16
  v_add_u32 v246, 8388608, v246
  v_and_b32 v247, 31, v0
  v_cmp_eq_u32 vcc, 0, v247
  v_mov_b32 v247, 2147418112
  s_nop 0
  v_cndmask_b32 v246, v247, v246, vcc
  s_lshl_b32 s50, s63, 3
  s_lshl_b32 s53, s5, 1
  s_add_u32 s50, s50, s53
  s_mul_i32 s53, s50, 205
  s_lshr_b32 s53, s53, 10
  s_mul_i32 s53, s53, 235
  s_add_u32 s50, s50, s53
  s_mul_i32 s53, s62, 5
  s_add_u32 s50, s50, s53
  s_lshl_b32 s50, s50, 10
  s_add_u32 s50, s50, 6291456
  s_lshl_b32 s51, s63, 3
  s_lshl_b32 s53, s5, 1
  s_add_u32 s51, s51, s53
  s_add_u32 s51, s51, 1
  s_mul_i32 s53, s51, 205
  s_lshr_b32 s53, s53, 10
  s_mul_i32 s53, s53, 235
  s_add_u32 s51, s51, s53
  s_mul_i32 s53, s62, 5
  s_add_u32 s51, s51, s53
  s_lshl_b32 s51, s51, 10
  s_add_u32 s51, s51, 6291456
  s_mul_i32 s58, s63, 48
  s_add_u32 s58, s58, s62
  s_mul_i32 s54, s7, 240
  s_mul_i32 s55, s5, 60
  s_add_u32 s54, s54, s55
  s_lshl_b32 s54, s54, 10
  s_add_u32 s54, s54, 6291456
  s_mov_b32 s62, s54
  s_add_u32 s53, s3, s7
  s_mov_b32 s53, 0
  s_add_u32 s54, s53, 0
  s_and_b32 s54, s54, 3
  s_mul_i32 s8, s54, 3072
  s_add_u32 s54, s53, 1
  s_and_b32 s54, s54, 3
  s_mul_i32 s9, s54, 3072
  s_add_u32 s54, s53, 2
  s_and_b32 s54, s54, 3
  s_mul_i32 s10, s54, 3072
  s_add_u32 s54, s53, 3
  s_and_b32 s54, s54, 3
  s_mul_i32 s11, s54, 3072
  s_cmp_ge_u32 s2, 240
  s_cselect_b32 s54, s2, s58
  s_lshl_b32 s54, s54, 3
  s_add_u32 s54, s54, 8454144
  s_lshl_b32 s55, s3, 1
  s_lshr_b32 s53, s5, 1
  s_add_u32 s55, s55, s53
  s_lshl_b32 s55, s55, 4
  s_add_u32 s55, s55, s4
  s_lshl_b32 s55, s55, 1
  s_and_b32 s53, s5, 1
  s_add_u32 s55, s55, s53
  s_lshl_b32 s55, s55, 3
  s_add_u32 s55, s55, 8458240
  s_cmp_eq_u32 s5, 0
  s_cselect_b32 s54, s54, 2147418112
  v_mov_b32 v16, s54
  v_mov_b32 v15, s55
  v_cmp_eq_u32 vcc, 0, v0
  s_nop 1
  v_cndmask_b32 v16, v247, v16, vcc
  v_cndmask_b32 v15, v247, v15, vcc
  s_mul_i32 s54, s7, 80
  s_lshr_b32 s54, s54, 7
  s_min_u32 s54, s54, 3
  s_mul_i32 s54, s54, 384
  s_add_u32 s54, s54, 8454144
  s_cmp_eq_u32 s5, 0
  s_cselect_b32 s54, s54, 2147418112
  v_min_u32 v19, 47, v0
  v_lshlrev_b32 v19, 4, v19
  v_add_u32 v19, s54, v19
  s_waitcnt lgkmcnt(0)
  s_mul_i32 s44, s44, 0x9e3779b1
  s_add_u32 s44, s44, 0x7f4a7c15
  s_mul_i32 s45, s45, 0x85ebca6b
  s_add_u32 s45, s45, 0xc2b2ae35
  s_add_u32 m0, s56, 57344
  s_add_u32 s49, s48, 256
  buffer_load_dwordx4 v2, s[24:27], s49 offen lds
  buffer_load_dwordx4 v3, s[24:27], s49 offen offset:1024 lds
  buffer_load_dwordx4 v254, s[24:27], s49 offen offset:2048 lds
  buffer_load_dwordx4 v255, s[24:27], s49 offen offset:3072 lds
  s_add_u32 m0, s57, 57344
  s_add_u32 s52, s52, 196608
  buffer_load_dwordx4 v4, s[28:31], s52 offen lds
  buffer_load_dwordx4 v5, s[28:31], s52 offen offset:1024 lds
  buffer_load_dwordx4 v6, s[28:31], s52 offen offset:2048 lds
  s_waitcnt vmcnt(22)
  s_waitcnt vmcnt(20)
  s_barrier
  ds_read_b128 v[188:191], v7 offset:0
  ds_read_b128 v[192:195], v7 offset:2048
  ds_read_b64_tr_b16 v[140:141], v11 offset:0
  ds_read_b64_tr_b16 v[142:143], v11 offset:768
  ds_read_b64_tr_b16 v[144:145], v13 offset:0
  ds_read_b64_tr_b16 v[146:147], v13 offset:768
  ds_read_b64_tr_b16 v[148:149], v11 offset:64
  ds_read_b64_tr_b16 v[150:151], v11 offset:832
  ds_read_b64_tr_b16 v[152:153], v13 offset:64
  ds_read_b64_tr_b16 v[154:155], v13 offset:832
  ds_read_b64_tr_b16 v[156:157], v11 offset:128
  ds_read_b64_tr_b16 v[158:159], v11 offset:896
  ds_read_b64_tr_b16 v[160:161], v13 offset:128
  ds_read_b64_tr_b16 v[162:163], v13 offset:896
  ds_read_b64_tr_b16 v[116:117], v17 offset:0
  s_waitcnt lgkmcnt(14)
  ds_read_b64_tr_b16 v[118:119], v17 offset:4096
  s_waitcnt lgkmcnt(14)
  ds_read_b64_tr_b16 v[120:121], v17 offset:32
  s_waitcnt lgkmcnt(14)
  ds_read_b64_tr_b16 v[122:123], v17 offset:4128
  s_waitcnt lgkmcnt(0)
  buffer_store_dwordx4 v[116:119], v1, s[36:39], s50 offen sc1
  buffer_store_dwordx4 v[120:123], v1, s[36:39], s51 offen sc1
  s_add_u32 m0, s56, 86016
  s_add_u32 s49, s48, 384
  buffer_load_dwordx4 v2, s[24:27], s49 offen lds
  buffer_load_dwordx4 v3, s[24:27], s49 offen offset:1024 lds
  v_mfma_f32_16x16x32_bf16 v[44:47], v[140:143], v[188:191], 0
  ds_read_b128 v[196:199], v9 offset:0
  ds_read_b128 v[200:203], v9 offset:2048
  v_mfma_f32_16x16x32_bf16 v[48:51], v[140:143], v[192:195], 0
  ds_read_b64_tr_b16 v[164:165], v11 offset:6144
  ds_read_b64_tr_b16 v[166:167], v11 offset:6912
  v_mfma_f32_16x16x32_bf16 v[52:55], v[144:147], v[188:191], 0
  ds_read_b64_tr_b16 v[168:169], v13 offset:6144
  buffer_load_dwordx4 v254, s[24:27], s49 offen offset:2048 lds
  v_mfma_f32_16x16x32_bf16 v[56:59], v[144:147], v[192:195], 0
  ds_read_b64_tr_b16 v[170:171], v13 offset:6912
  v_mfma_f32_16x16x32_bf16 v[60:63], v[148:151], v[188:191], 0
  ds_read_b64_tr_b16 v[172:173], v11 offset:6208
  v_mfma_f32_16x16x32_bf16 v[64:67], v[148:151], v[192:195], 0
  ds_read_b64_tr_b16 v[174:175], v11 offset:6976
  buffer_load_dwordx4 v255, s[24:27], s49 offen offset:3072 lds
  v_mfma_f32_16x16x32_bf16 v[68:71], v[152:155], v[188:191], 0
  ds_read_b64_tr_b16 v[176:177], v13 offset:6208
  v_mfma_f32_16x16x32_bf16 v[72:75], v[152:155], v[192:195], 0
  ds_read_b64_tr_b16 v[178:179], v13 offset:6976
  v_mfma_f32_16x16x32_bf16 v[76:79], v[156:159], v[188:191], 0
  ds_read_b64_tr_b16 v[180:181], v11 offset:6272
  s_add_u32 m0, s57, 86016
  s_add_u32 s52, s52, 196608
  buffer_load_dwordx4 v4, s[28:31], s52 offen lds
  v_mfma_f32_16x16x32_bf16 v[80:83], v[156:159], v[192:195], 0
  ds_read_b64_tr_b16 v[182:183], v11 offset:7040
  v_mfma_f32_16x16x32_bf16 v[84:87], v[160:163], v[188:191], 0
  ds_read_b64_tr_b16 v[184:185], v13 offset:6272
  v_mfma_f32_16x16x32_bf16 v[88:91], v[160:163], v[192:195], 0
  ds_read_b64_tr_b16 v[186:187], v13 offset:7040
  buffer_load_dwordx4 v5, s[28:31], s52 offen offset:1024 lds
  s_cmp_eq_u32 s5, 0
  s_cbranch_scc0 L_cs0
  v_mfma_f32_16x16x32_bf16 v[92:95], v[140:143], v[20:23], 0
  v_mfma_f32_16x16x32_bf16 v[96:99], v[144:147], v[20:23], 0
  v_mfma_f32_16x16x32_bf16 v[100:103], v[148:151], v[20:23], 0
  v_mfma_f32_16x16x32_bf16 v[104:107], v[152:155], v[20:23], 0
  v_mfma_f32_16x16x32_bf16 v[108:111], v[156:159], v[20:23], 0
  v_mfma_f32_16x16x32_bf16 v[112:115], v[160:163], v[20:23], 0
L_cs0:
  buffer_load_dwordx4 v6, s[28:31], s52 offen offset:2048 lds
  v_lshlrev_b32 v216, 16, v206
  v_and_b32 v217, 0xffff0000, v206
  v_lshlrev_b32 v218, 16, v207
  v_and_b32 v219, 0xffff0000, v207
  v_lshlrev_b32 v220, 16, v208
  v_and_b32 v221, 0xffff0000, v208
  v_lshlrev_b32 v222, 16, v209
  v_and_b32 v223, 0xffff0000, v209
  v_lshlrev_b32 v224, 16, v210
  v_and_b32 v225, 0xffff0000, v210
  v_lshlrev_b32 v226, 16, v211
  v_and_b32 v227, 0xffff0000, v211
  v_lshlrev_b32 v228, 16, v212
  v_and_b32 v229, 0xffff0000, v212
  v_lshlrev_b32 v230, 16, v213
  v_and_b32 v231, 0xffff0000, v213
  v_lshlrev_b32 v232, 16, v214
  v_and_b32 v233, 0xffff0000, v214
  v_lshlrev_b32 v234, 16, v215
  v_and_b32 v235, 0xffff0000, v215
  v_add_f32 v236, v216, v220
  v_add_f32 v237, v217, v221
  v_add_f32 v238, v218, v222
  s_waitcnt lgkmcnt(0)
  s_waitcnt vmcnt(22)
  s_barrier
  v_mfma_f32_16x16x32_bf16 v[44:47], v[164:167], v[196:199], v[44:47]
  ds_read_b128 v[188:191], v7 offset:28672
  ds_read_b128 v[192:195], v7 offset:30720
  v_add_f32 v239, v219, v223
  v_mfma_f32_16x16x32_bf16 v[48:51], v[164:167], v[200:203], v[48:51]
  ds_read_b64_tr_b16 v[140:141], v11 offset:28672
  ds_read_b64_tr_b16 v[142:143], v11 offset:29440
  v_add_f32 v236, v236, v224
  v_mfma_f32_16x16x32_bf16 v[52:55], v[168:171], v[196:199], v[52:55]
  ds_read_b64_tr_b16 v[144:145], v13 offset:28672
  s_add_u32 m0, s56, 0
  s_add_u32 s49, s48, 512
  buffer_load_dwordx4 v2, s[24:27], s49 offen lds
  v_mfma_f32_16x16x32_bf16 v[56:59], v[168:171], v[200:203], v[56:59]
  ds_read_b64_tr_b16 v[146:147], v13 offset:29440
  v_add_f32 v237, v237, v225
  v_mfma_f32_16x16x32_bf16 v[60:63], v[172:175], v[196:199], v[60:63]
  ds_read_b64_tr_b16 v[148:149], v11 offset:28736
  v_add_f32 v238, v238, v226
  v_mfma_f32_16x16x32_bf16 v[64:67], v[172:175], v[200:203], v[64:67]
  ds_read_b64_tr_b16 v[150:151], v11 offset:29504
  buffer_load_dwordx4 v3, s[24:27], s49 offen offset:1024 lds
  v_mfma_f32_16x16x32_bf16 v[68:71], v[176:179], v[196:199], v[68:71]
  ds_read_b64_tr_b16 v[152:153], v13 offset:28736
  v_add_f32 v239, v239, v227
  v_mfma_f32_16x16x32_bf16 v[72:75], v[176:179], v[200:203], v[72:75]
  ds_read_b64_tr_b16 v[154:155], v13 offset:29504
  v_add_f32 v236, v236, v228
  v_mfma_f32_16x16x32_bf16 v[76:79], v[180:183], v[196:199], v[76:79]
  ds_read_b64_tr_b16 v[156:157], v11 offset:28800
  buffer_load_dwordx4 v254, s[24:27], s49 offen offset:2048 lds
  v_mfma_f32_16x16x32_bf16 v[80:83], v[180:183], v[200:203], v[80:83]
  ds_read_b64_tr_b16 v[158:159], v11 offset:29568
  v_add_f32 v237, v237, v229
  v_mfma_f32_16x16x32_bf16 v[84:87], v[184:187], v[196:199], v[84:87]
  ds_read_b64_tr_b16 v[160:161], v13 offset:28800
  v_add_f32 v238, v238, v230
  v_mfma_f32_16x16x32_bf16 v[88:91], v[184:187], v[200:203], v[88:91]
  ds_read_b64_tr_b16 v[162:163], v13 offset:29568
  buffer_load_dwordx4 v255, s[24:27], s49 offen offset:3072 lds
  s_cmp_eq_u32 s5, 1
  s_cbranch_scc0 L_cs1
  v_mfma_f32_16x16x32_bf16 v[92:95], v[164:167], v[20:23], 0
  v_mfma_f32_16x16x32_bf16 v[96:99], v[168:171], v[20:23], 0
  v_mfma_f32_16x16x32_bf16 v[100:103], v[172:175], v[20:23], 0
  v_mfma_f32_16x16x32_bf16 v[104:107], v[176:179], v[20:23], 0
  v_mfma_f32_16x16x32_bf16 v[108:111], v[180:183], v[20:23], 0
  v_mfma_f32_16x16x32_bf16 v[112:115], v[184:187], v[20:23], 0
L_cs1:
  s_waitcnt lgkmcnt(8)
  v_mfma_f32_16x16x32_bf16 v[44:47], v[140:143], v[188:191], v[44:47]
  ds_read_b128 v[196:199], v9 offset:28672
  ds_read_b128 v[200:203], v9 offset:30720
  v_add_f32 v239, v239, v231
  v_mfma_f32_16x16x32_bf16 v[48:51], v[140:143], v[192:195], v[48:51]
  ds_read_b64_tr_b16 v[164:165], v11 offset:34816
  ds_read_b64_tr_b16 v[166:167], v11 offset:35584
  v_add_f32 v236, v236, v232
  v_mfma_f32_16x16x32_bf16 v[52:55], v[144:147], v[188:191], v[52:55]
  ds_read_b64_tr_b16 v[168:169], v13 offset:34816
  s_add_u32 m0, s57, 0
  s_add_u32 s52, s52, 196608
  buffer_load_dwordx4 v4, s[28:31], s52 offen lds
  v_mfma_f32_16x16x32_bf16 v[56:59], v[144:147], v[192:195], v[56:59]
  ds_read_b64_tr_b16 v[170:171], v13 offset:35584
  v_add_f32 v237, v237, v233
  s_waitcnt lgkmcnt(10)
  v_mfma_f32_16x16x32_bf16 v[60:63], v[148:151], v[188:191], v[60:63]
  ds_read_b64_tr_b16 v[172:173], v11 offset:34880
  v_add_f32 v238, v238, v234
  v_mfma_f32_16x16x32_bf16 v[64:67], v[148:151], v[192:195], v[64:67]
  ds_read_b64_tr_b16 v[174:175], v11 offset:35648
  buffer_load_dwordx4 v5, s[28:31], s52 offen offset:1024 lds
  v_mfma_f32_16x16x32_bf16 v[68:71], v[152:155], v[188:191], v[68:71]
  ds_read_b64_tr_b16 v[176:177], v13 offset:34880
  v_add_f32 v239, v239, v235
  v_mfma_f32_16x16x32_bf16 v[72:75], v[152:155], v[192:195], v[72:75]
  ds_read_b64_tr_b16 v[178:179], v13 offset:35648
  v_add_f32 v236, v236, v237
  s_waitcnt lgkmcnt(10)
  v_mfma_f32_16x16x32_bf16 v[76:79], v[156:159], v[188:191], v[76:79]
  ds_read_b64_tr_b16 v[180:181], v11 offset:34944
  buffer_load_dwordx4 v6, s[28:31], s52 offen offset:2048 lds
  v_mfma_f32_16x16x32_bf16 v[80:83], v[156:159], v[192:195], v[80:83]
  ds_read_b64_tr_b16 v[182:183], v11 offset:35712
  v_add_f32 v238, v238, v239
  v_mfma_f32_16x16x32_bf16 v[84:87], v[160:163], v[188:191], v[84:87]
  ds_read_b64_tr_b16 v[184:185], v13 offset:34944
  v_add_f32 v206, v236, v238
  v_mfma_f32_16x16x32_bf16 v[88:91], v[160:163], v[192:195], v[88:91]
  ds_read_b64_tr_b16 v[186:187], v13 offset:35712
  s_cmp_eq_u32 s5, 2
  s_cbranch_scc0 L_cs2
  v_mfma_f32_16x16x32_bf16 v[92:95], v[140:143], v[20:23], 0
  v_mfma_f32_16x16x32_bf16 v[96:99], v[144:147], v[20:23], 0
  v_mfma_f32_16x16x32_bf16 v[100:103], v[148:151], v[20:23], 0
  v_mfma_f32_16x16x32_bf16 v[104:107], v[152:155], v[20:23], 0
  v_mfma_f32_16x16x32_bf16 v[108:111], v[156:159], v[20:23], 0
  v_mfma_f32_16x16x32_bf16 v[112:115], v[160:163], v[20:23], 0
L_cs2:
  v_add_f32_dpp v206, v206, v206 quad_perm:[1,0,3,2] row_mask:0xf bank_mask:0xf
  s_nop 1
  v_add_f32_dpp v206, v206, v206 quad_perm:[2,3,0,1] row_mask:0xf bank_mask:0xf
  s_nop 1
  v_add_f32_dpp v206, v206, v206 row_half_mirror row_mask:0xf bank_mask:0xf
  s_nop 1
  v_add_f32_dpp v206, v206, v206 row_mirror row_mask:0xf bank_mask:0xf
  v_mov_b32 v207, v206
  s_nop 1
  v_permlane16_swap_b32 v206, v207
  v_add_f32 v206, v206, v207
  v_mul_f32 v206, 0xbacccccd, v206
  v_add_f32 v216, v216, v206
  v_add_f32 v217, v217, v206
  v_add_f32 v218, v218, v206
  v_add_f32 v219, v219, v206
  v_add_f32 v220, v220, v206
  v_add_f32 v221, v221, v206
  v_add_f32 v222, v222, v206
  v_add_f32 v223, v223, v206
  v_add_f32 v224, v224, v206
  v_add_f32 v225, v225, v206
  v_add_f32 v226, v226, v206
  v_add_f32 v227, v227, v206
  v_add_f32 v228, v228, v206
  v_add_f32 v229, v229, v206
  v_add_f32 v230, v230, v206
  v_add_f32 v231, v231, v206
  s_waitcnt lgkmcnt(0)
  s_waitcnt vmcnt(16)
  s_waitcnt vmcnt(14)
  s_barrier
  v_mfma_f32_16x16x32_bf16 v[44:47], v[164:167], v[196:199], v[44:47]
  ds_read_b128 v[188:191], v8 offset:0
  ds_read_b128 v[192:195], v8 offset:2048
  v_add_f32 v232, v232, v206
  v_mfma_f32_16x16x32_bf16 v[48:51], v[164:167], v[200:203], v[48:51]
  ds_read_b64_tr_b16 v[140:141], v12 offset:0
  ds_read_b64_tr_b16 v[142:143], v12 offset:768
  v_add_f32 v233, v233, v206
  v_mfma_f32_16x16x32_bf16 v[52:55], v[168:171], v[196:199], v[52:55]
  ds_read_b64_tr_b16 v[144:145], v14 offset:0
  v_mov_b32 v252, s44
  v_mov_b32 v253, s45
  buffer_store_dwordx2 v[252:253], v16, s[36:39], 0 offen sc1
  v_mfma_f32_16x16x32_bf16 v[56:59], v[168:171], v[200:203], v[56:59]
  ds_read_b64_tr_b16 v[146:147], v14 offset:768
  v_add_f32 v234, v234, v206
  v_mfma_f32_16x16x32_bf16 v[60:63], v[172:175], v[196:199], v[60:63]
  ds_read_b64_tr_b16 v[148:149], v12 offset:64
  v_add_f32 v235, v235, v206
  v_mfma_f32_16x16x32_bf16 v[64:67], v[172:175], v[200:203], v[64:67]
  ds_read_b64_tr_b16 v[150:151], v12 offset:832
  s_add_u32 m0, s56, 28672
  s_add_u32 s49, s23, 0
  buffer_load_dwordx4 v2, s[24:27], s49 offen lds
  v_mfma_f32_16x16x32_bf16 v[68:71], v[176:179], v[196:199], v[68:71]
  ds_read_b64_tr_b16 v[152:153], v14 offset:64
  v_mul_f32 v236, v216, v216
  v_mfma_f32_16x16x32_bf16 v[72:75], v[176:179], v[200:203], v[72:75]
  ds_read_b64_tr_b16 v[154:155], v14 offset:832
  v_mul_f32 v237, v217, v217
  v_mfma_f32_16x16x32_bf16 v[76:79], v[180:183], v[196:199], v[76:79]
  ds_read_b64_tr_b16 v[156:157], v12 offset:128
  buffer_load_dwordx4 v3, s[24:27], s49 offen offset:1024 lds
  v_mfma_f32_16x16x32_bf16 v[80:83], v[180:183], v[200:203], v[80:83]
  ds_read_b64_tr_b16 v[158:159], v12 offset:896
  v_mul_f32 v238, v218, v218
  v_mfma_f32_16x16x32_bf16 v[84:87], v[184:187], v[196:199], v[84:87]
  ds_read_b64_tr_b16 v[160:161], v14 offset:128
  v_mul_f32 v239, v219, v219
  v_mfma_f32_16x16x32_bf16 v[88:91], v[184:187], v[200:203], v[88:91]
  ds_read_b64_tr_b16 v[162:163], v14 offset:896
  buffer_load_dwordx4 v254, s[24:27], s49 offen offset:2048 lds
  s_cmp_eq_u32 s5, 3
  s_cbranch_scc0 L_cs3
  v_mfma_f32_16x16x32_bf16 v[92:95], v[164:167], v[20:23], 0
  v_mfma_f32_16x16x32_bf16 v[96:99], v[168:171], v[20:23], 0
  v_mfma_f32_16x16x32_bf16 v[100:103], v[172:175], v[20:23], 0
  v_mfma_f32_16x16x32_bf16 v[104:107], v[176:179], v[20:23], 0
  v_mfma_f32_16x16x32_bf16 v[108:111], v[180:183], v[20:23], 0
  v_mfma_f32_16x16x32_bf16 v[112:115], v[184:187], v[20:23], 0
L_cs3:
  s_waitcnt lgkmcnt(8)
  v_mfma_f32_16x16x32_bf16 v[44:47], v[140:143], v[188:191], v[44:47]
  ds_read_b128 v[196:199], v10 offset:0
  ds_read_b128 v[200:203], v10 offset:2048
  v_fmac_f32 v236, v220, v220
  v_mfma_f32_16x16x32_bf16 v[48:51], v[140:143], v[192:195], v[48:51]
  ds_read_b64_tr_b16 v[164:165], v12 offset:6144
  ds_read_b64_tr_b16 v[166:167], v12 offset:6912
  v_fmac_f32 v237, v221, v221
  v_mfma_f32_16x16x32_bf16 v[52:55], v[144:147], v[188:191], v[52:55]
  ds_read_b64_tr_b16 v[168:169], v14 offset:6144
  buffer_load_dwordx4 v255, s[24:27], s49 offen offset:3072 lds
  v_mfma_f32_16x16x32_bf16 v[56:59], v[144:147], v[192:195], v[56:59]
  ds_read_b64_tr_b16 v[170:171], v14 offset:6912
  v_fmac_f32 v238, v222, v222
  s_waitcnt lgkmcnt(10)
  v_mfma_f32_16x16x32_bf16 v[60:63], v[148:151], v[188:191], v[60:63]
  ds_read_b64_tr_b16 v[172:173], v12 offset:6208
  v_fmac_f32 v239, v223, v223
  v_mfma_f32_16x16x32_bf16 v[64:67], v[148:151], v[192:195], v[64:67]
  ds_read_b64_tr_b16 v[174:175], v12 offset:6976
  s_add_u32 m0, s57, 28672
  s_add_u32 s52, s52, s22
  buffer_load_dwordx4 v4, s[28:31], s52 offen lds
  v_mfma_f32_16x16x32_bf16 v[68:71], v[152:155], v[188:191], v[68:71]
  ds_read_b64_tr_b16 v[176:177], v14 offset:6208
  v_fmac_f32 v236, v224, v224
  v_mfma_f32_16x16x32_bf16 v[72:75], v[152:155], v[192:195], v[72:75]
  ds_read_b64_tr_b16 v[178:179], v14 offset:6976
  v_fmac_f32 v237, v225, v225
  s_waitcnt lgkmcnt(10)
  v_mfma_f32_16x16x32_bf16 v[76:79], v[156:159], v[188:191], v[76:79]
  ds_read_b64_tr_b16 v[180:181], v12 offset:6272
  buffer_load_dwordx4 v5, s[28:31], s52 offen offset:1024 lds
  v_mfma_f32_16x16x32_bf16 v[80:83], v[156:159], v[192:195], v[80:83]
  ds_read_b64_tr_b16 v[182:183], v12 offset:7040
  v_fmac_f32 v238, v226, v226
  v_mfma_f32_16x16x32_bf16 v[84:87], v[160:163], v[188:191], v[84:87]
  ds_read_b64_tr_b16 v[184:185], v14 offset:6272
  v_fmac_f32 v239, v227, v227
  v_mfma_f32_16x16x32_bf16 v[88:91], v[160:163], v[192:195], v[88:91]
  ds_read_b64_tr_b16 v[186:187], v14 offset:7040
  buffer_load_dwordx4 v6, s[28:31], s52 offen offset:2048 lds
  s_cmp_eq_u32 s5, 0
  s_cbranch_scc0 L_cs4
  v_mfma_f32_16x16x32_bf16 v[92:95], v[140:143], v[20:23], v[92:95]
  v_mfma_f32_16x16x32_bf16 v[96:99], v[144:147], v[20:23], v[96:99]
  v_mfma_f32_16x16x32_bf16 v[100:103], v[148:151], v[20:23], v[100:103]
  v_mfma_f32_16x16x32_bf16 v[104:107], v[152:155], v[20:23], v[104:107]
  v_mfma_f32_16x16x32_bf16 v[108:111], v[156:159], v[20:23], v[108:111]
  v_mfma_f32_16x16x32_bf16 v[112:115], v[160:163], v[20:23], v[112:115]
L_cs4:
  v_fmac_f32 v236, v228, v228
  v_fmac_f32 v237, v229, v229
  v_fmac_f32 v238, v230, v230
  v_fmac_f32 v239, v231, v231
  v_fmac_f32 v236, v232, v232
  v_fmac_f32 v237, v233, v233
  v_fmac_f32 v238, v234, v234
  v_fmac_f32 v239, v235, v235
  v_add_f32 v236, v236, v237
  v_add_f32 v238, v238, v239
  v_add_f32 v207, v236, v238
  s_nop 1
  v_add_f32_dpp v207, v207, v207 quad_perm:[1,0,3,2] row_mask:0xf bank_mask:0xf
  s_nop 1
  v_add_f32_dpp v207, v207, v207 quad_perm:[2,3,0,1] row_mask:0xf bank_mask:0xf
  s_nop 1
  v_add_f32_dpp v207, v207, v207 row_half_mirror row_mask:0xf bank_mask:0xf
  s_nop 1
  v_add_f32_dpp v207, v207, v207 row_mirror row_mask:0xf bank_mask:0xf
  v_mov_b32 v208, v207
  s_nop 1
  v_permlane16_swap_b32 v207, v208
  v_add_f32 v207, v207, v208
  v_mul_f32 v207, 0x3acccccd, v207
  v_cvt_pk_bf16_f32 v208, v206, v207
  v_lshlrev_b32 v206, 16, v208
  v_and_b32 v207, 0xffff0000, v208
  v_add_f32 v207, 0x3727c5ac, v207
  v_cvt_pk_bf16_f32 v207, v207, v207
  s_waitcnt lgkmcnt(0)
  s_waitcnt vmcnt(15)
  s_barrier
  v_mfma_f32_16x16x32_bf16 v[44:47], v[164:167], v[196:199], v[44:47]
  ds_read_b128 v[188:191], v8 offset:28672
  ds_read_b128 v[192:195], v8 offset:30720
  v_lshlrev_b32 v207, 16, v207
  v_mfma_f32_16x16x32_bf16 v[48:51], v[164:167], v[200:203], v[48:51]
  ds_read_b64_tr_b16 v[140:141], v12 offset:28672
  ds_read_b64_tr_b16 v[142:143], v12 offset:29440
  v_sqrt_f32 v207, v207
  v_mfma_f32_16x16x32_bf16 v[52:55], v[168:171], v[196:199], v[52:55]
  ds_read_b64_tr_b16 v[144:145], v14 offset:28672
  s_add_u32 m0, s56, 57344
  s_add_u32 s49, s23, 128
  buffer_load_dwordx4 v2, s[24:27], s49 offen lds
  v_mfma_f32_16x16x32_bf16 v[56:59], v[168:171], v[200:203], v[56:59]
  ds_read_b64_tr_b16 v[146:147], v14 offset:29440
  v_cvt_pk_bf16_f32 v207, v207, v207
  v_mfma_f32_16x16x32_bf16 v[60:63], v[172:175], v[196:199], v[60:63]
  ds_read_b64_tr_b16 v[148:149], v12 offset:28736
  v_lshlrev_b32 v207, 16, v207
  v_mfma_f32_16x16x32_bf16 v[64:67], v[172:175], v[200:203], v[64:67]
  ds_read_b64_tr_b16 v[150:151], v12 offset:29504
  buffer_load_dwordx4 v3, s[24:27], s49 offen offset:1024 lds
  v_mfma_f32_16x16x32_bf16 v[68:71], v[176:179], v[196:199], v[68:71]
  ds_read_b64_tr_b16 v[152:153], v14 offset:28736
  v_rcp_f32 v209, v207
  v_mfma_f32_16x16x32_bf16 v[72:75], v[176:179], v[200:203], v[72:75]
  ds_read_b64_tr_b16 v[154:155], v14 offset:29504
  v_mul_f32 v208, v206, v209
  v_mfma_f32_16x16x32_bf16 v[76:79], v[180:183], v[196:199], v[76:79]
  ds_read_b64_tr_b16 v[156:157], v12 offset:28800
  buffer_load_dwordx4 v254, s[24:27], s49 offen offset:2048 lds
  v_mfma_f32_16x16x32_bf16 v[80:83], v[180:183], v[200:203], v[80:83]
  ds_read_b64_tr_b16 v[158:159], v12 offset:29568
  v_mov_b32 v210, s44
  v_mfma_f32_16x16x32_bf16 v[84:87], v[184:187], v[196:199], v[84:87]
  ds_read_b64_tr_b16 v[160:161], v14 offset:28800
  v_mov_b32 v211, s45
  v_mfma_f32_16x16x32_bf16 v[88:91], v[184:187], v[200:203], v[88:91]
  ds_read_b64_tr_b16 v[162:163], v14 offset:29568
  buffer_load_dwordx4 v255, s[24:27], s49 offen offset:3072 lds
  s_cmp_eq_u32 s5, 1
  s_cbranch_scc0 L_cs5
  v_mfma_f32_16x16x32_bf16 v[92:95], v[164:167], v[20:23], v[92:95]
  v_mfma_f32_16x16x32_bf16 v[96:99], v[168:171], v[20:23], v[96:99]
  v_mfma_f32_16x16x32_bf16 v[100:103], v[172:175], v[20:23], v[100:103]
  v_mfma_f32_16x16x32_bf16 v[104:107], v[176:179], v[20:23], v[104:107]
  v_mfma_f32_16x16x32_bf16 v[108:111], v[180:183], v[20:23], v[108:111]
  v_mfma_f32_16x16x32_bf16 v[112:115], v[184:187], v[20:23], v[112:115]
L_cs5:
  s_waitcnt lgkmcnt(8)
  v_mfma_f32_16x16x32_bf16 v[44:47], v[140:143], v[188:191], v[44:47]
  ds_read_b128 v[196:199], v10 offset:28672
  ds_read_b128 v[200:203], v10 offset:30720
  buffer_store_dwordx4 v[208:211], v246, s[36:39], 0 offen sc1
  v_mfma_f32_16x16x32_bf16 v[48:51], v[140:143], v[192:195], v[48:51]
  ds_read_b64_tr_b16 v[164:165], v12 offset:34816
  ds_read_b64_tr_b16 v[166:167], v12 offset:35584
  v_mfma_f32_16x16x32_bf16 v[52:55], v[144:147], v[188:191], v[52:55]
  ds_read_b64_tr_b16 v[168:169], v14 offset:34816
  s_add_u32 m0, s57, 57344
  s_add_u32 s52, s52, 196608
  buffer_load_dwordx4 v4, s[28:31], s52 offen lds
  v_mfma_f32_16x16x32_bf16 v[56:59], v[144:147], v[192:195], v[56:59]
  ds_read_b64_tr_b16 v[170:171], v14 offset:35584
  s_waitcnt lgkmcnt(10)
  v_mfma_f32_16x16x32_bf16 v[60:63], v[148:151], v[188:191], v[60:63]
  ds_read_b64_tr_b16 v[172:173], v12 offset:34880
  v_mfma_f32_16x16x32_bf16 v[64:67], v[148:151], v[192:195], v[64:67]
  ds_read_b64_tr_b16 v[174:175], v12 offset:35648
  buffer_load_dwordx4 v5, s[28:31], s52 offen offset:1024 lds
  v_mfma_f32_16x16x32_bf16 v[68:71], v[152:155], v[188:191], v[68:71]
  ds_read_b64_tr_b16 v[176:177], v14 offset:34880
  v_mfma_f32_16x16x32_bf16 v[72:75], v[152:155], v[192:195], v[72:75]
  ds_read_b64_tr_b16 v[178:179], v14 offset:35648
  s_waitcnt lgkmcnt(10)
  v_mfma_f32_16x16x32_bf16 v[76:79], v[156:159], v[188:191], v[76:79]
  ds_read_b64_tr_b16 v[180:181], v12 offset:34944
  buffer_load_dwordx4 v6, s[28:31], s52 offen offset:2048 lds
  v_mfma_f32_16x16x32_bf16 v[80:83], v[156:159], v[192:195], v[80:83]
  ds_read_b64_tr_b16 v[182:183], v12 offset:35712
  v_mfma_f32_16x16x32_bf16 v[84:87], v[160:163], v[188:191], v[84:87]
  ds_read_b64_tr_b16 v[184:185], v14 offset:34944
  v_mfma_f32_16x16x32_bf16 v[88:91], v[160:163], v[192:195], v[88:91]
  ds_read_b64_tr_b16 v[186:187], v14 offset:35712
  s_cmp_eq_u32 s5, 2
  s_cbranch_scc0 L_cs6
  v_mfma_f32_16x16x32_bf16 v[92:95], v[140:143], v[20:23], v[92:95]
  v_mfma_f32_16x16x32_bf16 v[96:99], v[144:147], v[20:23], v[96:99]
  v_mfma_f32_16x16x32_bf16 v[100:103], v[148:151], v[20:23], v[100:103]
  v_mfma_f32_16x16x32_bf16 v[104:107], v[152:155], v[20:23], v[104:107]
  v_mfma_f32_16x16x32_bf16 v[108:111], v[156:159], v[20:23], v[108:111]
  v_mfma_f32_16x16x32_bf16 v[112:115], v[160:163], v[20:23], v[112:115]
L_cs6:
  s_waitcnt lgkmcnt(0)
  s_waitcnt vmcnt(16)
  s_barrier
  v_mfma_f32_16x16x32_bf16 v[44:47], v[164:167], v[196:199], v[44:47]
  ds_read_b128 v[188:191], v7 offset:0
  ds_read_b128 v[192:195], v7 offset:2048
  v_mfma_f32_16x16x32_bf16 v[48:51], v[164:167], v[200:203], v[48:51]
  ds_read_b64_tr_b16 v[140:141], v11 offset:0
  ds_read_b64_tr_b16 v[142:143], v11 offset:768
  v_mfma_f32_16x16x32_bf16 v[52:55], v[168:171], v[196:199], v[52:55]
  ds_read_b64_tr_b16 v[144:145], v13 offset:0
  s_add_u32 m0, s56, 86016
  s_add_u32 s49, s23, 256
  buffer_load_dwordx4 v2, s[24:27], s49 offen lds
  v_mfma_f32_16x16x32_bf16 v[56:59], v[168:171], v[200:203], v[56:59]
  ds_read_b64_tr_b16 v[146:147], v13 offset:768
  v_mfma_f32_16x16x32_bf16 v[60:63], v[172:175], v[196:199], v[60:63]
  ds_read_b64_tr_b16 v[148:149], v11 offset:64
  v_mfma_f32_16x16x32_bf16 v[64:67], v[172:175], v[200:203], v[64:67]
  ds_read_b64_tr_b16 v[150:151], v11 offset:832
  buffer_load_dwordx4 v3, s[24:27], s49 offen offset:1024 lds
  v_mfma_f32_16x16x32_bf16 v[68:71], v[176:179], v[196:199], v[68:71]
  ds_read_b64_tr_b16 v[152:153], v13 offset:64
  v_mfma_f32_16x16x32_bf16 v[72:75], v[176:179], v[200:203], v[72:75]
  ds_read_b64_tr_b16 v[154:155], v13 offset:832
  v_mfma_f32_16x16x32_bf16 v[76:79], v[180:183], v[196:199], v[76:79]
  ds_read_b64_tr_b16 v[156:157], v11 offset:128
  buffer_load_dwordx4 v254, s[24:27], s49 offen offset:2048 lds
  v_mfma_f32_16x16x32_bf16 v[80:83], v[180:183], v[200:203], v[80:83]
  ds_read_b64_tr_b16 v[158:159], v11 offset:896
  v_mfma_f32_16x16x32_bf16 v[84:87], v[184:187], v[196:199], v[84:87]
  ds_read_b64_tr_b16 v[160:161], v13 offset:128
  v_mfma_f32_16x16x32_bf16 v[88:91], v[184:187], v[200:203], v[88:91]
  ds_read_b64_tr_b16 v[162:163], v13 offset:896
  buffer_load_dwordx4 v255, s[24:27], s49 offen offset:3072 lds
  s_cmp_eq_u32 s5, 3
  s_cbranch_scc0 L_cs7
  v_mfma_f32_16x16x32_bf16 v[92:95], v[164:167], v[20:23], v[92:95]
  v_mfma_f32_16x16x32_bf16 v[96:99], v[168:171], v[20:23], v[96:99]
  v_mfma_f32_16x16x32_bf16 v[100:103], v[172:175], v[20:23], v[100:103]
  v_mfma_f32_16x16x32_bf16 v[104:107], v[176:179], v[20:23], v[104:107]
  v_mfma_f32_16x16x32_bf16 v[108:111], v[180:183], v[20:23], v[108:111]
  v_mfma_f32_16x16x32_bf16 v[112:115], v[184:187], v[20:23], v[112:115]
L_cs7:
  s_waitcnt lgkmcnt(8)
  v_mfma_f32_16x16x32_bf16 v[44:47], v[140:143], v[188:191], v[44:47]
  ds_read_b128 v[196:199], v9 offset:0
  ds_read_b128 v[200:203], v9 offset:2048
  v_mfma_f32_16x16x32_bf16 v[48:51], v[140:143], v[192:195], v[48:51]
  ds_read_b64_tr_b16 v[164:165], v11 offset:6144
  ds_read_b64_tr_b16 v[166:167], v11 offset:6912
  v_mfma_f32_16x16x32_bf16 v[52:55], v[144:147], v[188:191], v[52:55]
  ds_read_b64_tr_b16 v[168:169], v13 offset:6144
  s_add_u32 m0, s57, 86016
  s_add_u32 s52, s52, 196608
  buffer_load_dwordx4 v4, s[28:31], s52 offen lds
  v_mfma_f32_16x16x32_bf16 v[56:59], v[144:147], v[192:195], v[56:59]
  ds_read_b64_tr_b16 v[170:171], v13 offset:6912
  s_waitcnt lgkmcnt(10)
  v_mfma_f32_16x16x32_bf16 v[60:63], v[148:151], v[188:191], v[60:63]
  ds_read_b64_tr_b16 v[172:173], v11 offset:6208
  v_mfma_f32_16x16x32_bf16 v[64:67], v[148:151], v[192:195], v[64:67]
  ds_read_b64_tr_b16 v[174:175], v11 offset:6976
  buffer_load_dwordx4 v5, s[28:31], s52 offen offset:1024 lds
  v_mfma_f32_16x16x32_bf16 v[68:71], v[152:155], v[188:191], v[68:71]
  ds_read_b64_tr_b16 v[176:177], v13 offset:6208
  v_mfma_f32_16x16x32_bf16 v[72:75], v[152:155], v[192:195], v[72:75]
  ds_read_b64_tr_b16 v[178:179], v13 offset:6976
  s_waitcnt lgkmcnt(10)
  v_mfma_f32_16x16x32_bf16 v[76:79], v[156:159], v[188:191], v[76:79]
  ds_read_b64_tr_b16 v[180:181], v11 offset:6272
  buffer_load_dwordx4 v6, s[28:31], s52 offen offset:2048 lds
  v_mfma_f32_16x16x32_bf16 v[80:83], v[156:159], v[192:195], v[80:83]
  ds_read_b64_tr_b16 v[182:183], v11 offset:7040
  v_mfma_f32_16x16x32_bf16 v[84:87], v[160:163], v[188:191], v[84:87]
  ds_read_b64_tr_b16 v[184:185], v13 offset:6272
  v_mfma_f32_16x16x32_bf16 v[88:91], v[160:163], v[192:195], v[88:91]
  ds_read_b64_tr_b16 v[186:187], v13 offset:7040
  s_cmp_eq_u32 s5, 0
  s_cbranch_scc0 L_cs8
  v_mfma_f32_16x16x32_bf16 v[92:95], v[140:143], v[20:23], v[92:95]
  v_mfma_f32_16x16x32_bf16 v[96:99], v[144:147], v[20:23], v[96:99]
  v_mfma_f32_16x16x32_bf16 v[100:103], v[148:151], v[20:23], v[100:103]
  v_mfma_f32_16x16x32_bf16 v[104:107], v[152:155], v[20:23], v[104:107]
  v_mfma_f32_16x16x32_bf16 v[108:111], v[156:159], v[20:23], v[108:111]
  v_mfma_f32_16x16x32_bf16 v[112:115], v[160:163], v[20:23], v[112:115]
L_cs8:
  s_waitcnt lgkmcnt(0)
  s_waitcnt vmcnt(15)
  s_barrier
  v_mfma_f32_16x16x32_bf16 v[44:47], v[164:167], v[196:199], v[44:47]
  ds_read_b128 v[188:191], v7 offset:28672
  ds_read_b128 v[192:195], v7 offset:30720
  v_lshlrev_b32 v204, 16, v24
  v_mfma_f32_16x16x32_bf16 v[48:51], v[164:167], v[200:203], v[48:51]
  ds_read_b64_tr_b16 v[140:141], v11 offset:28672
  ds_read_b64_tr_b16 v[142:143], v11 offset:29440
  v_and_b32 v205, 0xffff0000, v24
  v_mfma_f32_16x16x32_bf16 v[52:55], v[168:171], v[196:199], v[52:55]
  ds_read_b64_tr_b16 v[144:145], v13 offset:28672
  buffer_load_dwordx4 v[248:251], v19, s[36:39], 0 offen sc1
  v_mfma_f32_16x16x32_bf16 v[56:59], v[168:171], v[200:203], v[56:59]
  ds_read_b64_tr_b16 v[146:147], v13 offset:29440
  v_lshlrev_b32 v206, 16, v25
  v_mfma_f32_16x16x32_bf16 v[60:63], v[172:175], v[196:199], v[60:63]
  ds_read_b64_tr_b16 v[148:149], v11 offset:28736
  v_and_b32 v207, 0xffff0000, v25
  v_mfma_f32_16x16x32_bf16 v[64:67], v[172:175], v[200:203], v[64:67]
  ds_read_b64_tr_b16 v[150:151], v11 offset:29504
  s_add_u32 m0, s56, 0
  s_add_u32 s49, s23, 384
  buffer_load_dwordx4 v2, s[24:27], s49 offen lds
  v_mfma_f32_16x16x32_bf16 v[68:71], v[176:179], v[196:199], v[68:71]
  ds_read_b64_tr_b16 v[152:153], v13 offset:28736
  v_lshlrev_b32 v208, 16, v26
  v_mfma_f32_16x16x32_bf16 v[72:75], v[176:179], v[200:203], v[72:75]
  ds_read_b64_tr_b16 v[154:155], v13 offset:29504
  v_and_b32 v209, 0xffff0000, v26
  v_mfma_f32_16x16x32_bf16 v[76:79], v[180:183], v[196:199], v[76:79]
  ds_read_b64_tr_b16 v[156:157], v11 offset:28800
  buffer_load_dwordx4 v3, s[24:27], s49 offen offset:1024 lds
  v_mfma_f32_16x16x32_bf16 v[80:83], v[180:183], v[200:203], v[80:83]
  ds_read_b64_tr_b16 v[158:159], v11 offset:29568
  v_lshlrev_b32 v210, 16, v27
  v_mfma_f32_16x16x32_bf16 v[84:87], v[184:187], v[196:199], v[84:87]
  ds_read_b64_tr_b16 v[160:161], v13 offset:28800
  v_and_b32 v211, 0xffff0000, v27
  v_mfma_f32_16x16x32_bf16 v[88:91], v[184:187], v[200:203], v[88:91]
  ds_read_b64_tr_b16 v[162:163], v13 offset:29568
  buffer_load_dwordx4 v254, s[24:27], s49 offen offset:2048 lds
  s_cmp_eq_u32 s5, 1
  s_cbranch_scc0 L_cs9
  v_mfma_f32_16x16x32_bf16 v[92:95], v[164:167], v[20:23], v[92:95]
  v_mfma_f32_16x16x32_bf16 v[96:99], v[168:171], v[20:23], v[96:99]
  v_mfma_f32_16x16x32_bf16 v[100:103], v[172:175], v[20:23], v[100:103]
  v_mfma_f32_16x16x32_bf16 v[104:107], v[176:179], v[20:23], v[104:107]
  v_mfma_f32_16x16x32_bf16 v[108:111], v[180:183], v[20:23], v[108:111]
  v_mfma_f32_16x16x32_bf16 v[112:115], v[184:187], v[20:23], v[112:115]
L_cs9:
  s_waitcnt lgkmcnt(8)
  v_mfma_f32_16x16x32_bf16 v[44:47], v[140:143], v[188:191], v[44:47]
  ds_read_b128 v[196:199], v9 offset:28672
  ds_read_b128 v[200:203], v9 offset:30720
  v_lshlrev_b32 v212, 16, v28
  v_mfma_f32_16x16x32_bf16 v[48:51], v[140:143], v[192:195], v[48:51]
  ds_read_b64_tr_b16 v[164:165], v11 offset:34816
  ds_read_b64_tr_b16 v[166:167], v11 offset:35584
  v_and_b32 v213, 0xffff0000, v28
  v_mfma_f32_16x16x32_bf16 v[52:55], v[144:147], v[188:191], v[52:55]
  ds_read_b64_tr_b16 v[168:169], v13 offset:34816
  buffer_load_dwordx4 v255, s[24:27], s49 offen offset:3072 lds
  v_mfma_f32_16x16x32_bf16 v[56:59], v[144:147], v[192:195], v[56:59]
  ds_read_b64_tr_b16 v[170:171], v13 offset:35584
  v_lshlrev_b32 v214, 16, v29
  s_waitcnt lgkmcnt(10)
  v_mfma_f32_16x16x32_bf16 v[60:63], v[148:151], v[188:191], v[60:63]
  ds_read_b64_tr_b16 v[172:173], v11 offset:34880
  v_and_b32 v215, 0xffff0000, v29
  v_mfma_f32_16x16x32_bf16 v[64:67], v[148:151], v[192:195], v[64:67]
  ds_read_b64_tr_b16 v[174:175], v11 offset:35648
  s_add_u32 m0, s57, 0
  s_add_u32 s52, s52, 196608
  buffer_load_dwordx4 v4, s[28:31], s52 offen lds
  v_mfma_f32_16x16x32_bf16 v[68:71], v[152:155], v[188:191], v[68:71]
  ds_read_b64_tr_b16 v[176:177], v13 offset:34880
  v_lshlrev_b32 v216, 16, v30
  v_mfma_f32_16x16x32_bf16 v[72:75], v[152:155], v[192:195], v[72:75]
  ds_read_b64_tr_b16 v[178:179], v13 offset:35648
  v_and_b32 v217, 0xffff0000, v30
  s_waitcnt lgkmcnt(10)
  v_mfma_f32_16x16x32_bf16 v[76:79], v[156:159], v[188:191], v[76:79]
  ds_read_b64_tr_b16 v[180:181], v11 offset:34944
  buffer_load_dwordx4 v5, s[28:31], s52 offen offset:1024 lds
  v_mfma_f32_16x16x32_bf16 v[80:83], v[156:159], v[192:195], v[80:83]
  ds_read_b64_tr_b16 v[182:183], v11 offset:35712
  v_lshlrev_b32 v218, 16, v31
  v_mfma_f32_16x16x32_bf16 v[84:87], v[160:163], v[188:191], v[84:87]
  ds_read_b64_tr_b16 v[184:185], v13 offset:34944
  v_and_b32 v219, 0xffff0000, v31
  v_mfma_f32_16x16x32_bf16 v[88:91], v[160:163], v[192:195], v[88:91]
  ds_read_b64_tr_b16 v[186:187], v13 offset:35712
  buffer_load_dwordx4 v6, s[28:31], s52 offen offset:2048 lds
  s_cmp_eq_u32 s5, 2
  s_cbranch_scc0 L_cs10
  v_mfma_f32_16x16x32_bf16 v[92:95], v[140:143], v[20:23], v[92:95]
  v_mfma_f32_16x16x32_bf16 v[96:99], v[144:147], v[20:23], v[96:99]
  v_mfma_f32_16x16x32_bf16 v[100:103], v[148:151], v[20:23], v[100:103]
  v_mfma_f32_16x16x32_bf16 v[104:107], v[152:155], v[20:23], v[104:107]
  v_mfma_f32_16x16x32_bf16 v[108:111], v[156:159], v[20:23], v[108:111]
  v_mfma_f32_16x16x32_bf16 v[112:115], v[160:163], v[20:23], v[112:115]
L_cs10:
  v_lshlrev_b32 v220, 16, v32
  v_and_b32 v221, 0xffff0000, v32
  v_lshlrev_b32 v222, 16, v33
  v_and_b32 v223, 0xffff0000, v33
  v_lshlrev_b32 v224, 16, v34
  v_and_b32 v225, 0xffff0000, v34
  v_lshlrev_b32 v226, 16, v35
  v_and_b32 v227, 0xffff0000, v35
  s_waitcnt lgkmcnt(0)
  s_waitcnt vmcnt(15)
  s_barrier
  v_mfma_f32_16x16x32_bf16 v[44:47], v[164:167], v[196:199], v[44:47]
  ds_read_b128 v[188:191], v8 offset:0
  ds_read_b128 v[192:195], v8 offset:2048
  v_mfma_f32_16x16x32_bf16 v[48:51], v[164:167], v[200:203], v[48:51]
  ds_read_b64_tr_b16 v[140:141], v12 offset:0
  ds_read_b64_tr_b16 v[142:143], v12 offset:768
  v_mfma_f32_16x16x32_bf16 v[52:55], v[168:171], v[196:199], v[52:55]
  ds_read_b64_tr_b16 v[144:145], v14 offset:0
  s_add_u32 m0, s56, 28672
  s_add_u32 s49, s23, 512
  buffer_load_dwordx4 v2, s[24:27], s49 offen lds
  v_mfma_f32_16x16x32_bf16 v[56:59], v[168:171], v[200:203], v[56:59]
  ds_read_b64_tr_b16 v[146:147], v14 offset:768
  v_mfma_f32_16x16x32_bf16 v[60:63], v[172:175], v[196:199], v[60:63]
  ds_read_b64_tr_b16 v[148:149], v12 offset:64
  v_mfma_f32_16x16x32_bf16 v[64:67], v[172:175], v[200:203], v[64:67]
  ds_read_b64_tr_b16 v[150:151], v12 offset:832
  buffer_load_dwordx4 v3, s[24:27], s49 offen offset:1024 lds
  v_mfma_f32_16x16x32_bf16 v[68:71], v[176:179], v[196:199], v[68:71]
  ds_read_b64_tr_b16 v[152:153], v14 offset:64
  v_mfma_f32_16x16x32_bf16 v[72:75], v[176:179], v[200:203], v[72:75]
  ds_read_b64_tr_b16 v[154:155], v14 offset:832
  v_mfma_f32_16x16x32_bf16 v[76:79], v[180:183], v[196:199], v[76:79]
  ds_read_b64_tr_b16 v[156:157], v12 offset:128
  buffer_load_dwordx4 v254, s[24:27], s49 offen offset:2048 lds
  v_mfma_f32_16x16x32_bf16 v[80:83], v[180:183], v[200:203], v[80:83]
  ds_read_b64_tr_b16 v[158:159], v12 offset:896
  v_mfma_f32_16x16x32_bf16 v[84:87], v[184:187], v[196:199], v[84:87]
  ds_read_b64_tr_b16 v[160:161], v14 offset:128
  v_mfma_f32_16x16x32_bf16 v[88:91], v[184:187], v[200:203], v[88:91]
  ds_read_b64_tr_b16 v[162:163], v14 offset:896
  buffer_load_dwordx4 v255, s[24:27], s49 offen offset:3072 lds
  s_cmp_eq_u32 s5, 3
  s_cbranch_scc0 L_cs11
  v_mfma_f32_16x16x32_bf16 v[92:95], v[164:167], v[20:23], v[92:95]
  v_mfma_f32_16x16x32_bf16 v[96:99], v[168:171], v[20:23], v[96:99]
  v_mfma_f32_16x16x32_bf16 v[100:103], v[172:175], v[20:23], v[100:103]
  v_mfma_f32_16x16x32_bf16 v[104:107], v[176:179], v[20:23], v[104:107]
  v_mfma_f32_16x16x32_bf16 v[108:111], v[180:183], v[20:23], v[108:111]
  v_mfma_f32_16x16x32_bf16 v[112:115], v[184:187], v[20:23], v[112:115]
L_cs11:
  s_waitcnt lgkmcnt(8)
  v_mfma_f32_16x16x32_bf16 v[44:47], v[140:143], v[188:191], v[44:47]
  ds_read_b128 v[196:199], v10 offset:0
  ds_read_b128 v[200:203], v10 offset:2048
  v_mfma_f32_16x16x32_bf16 v[48:51], v[140:143], v[192:195], v[48:51]
  ds_read_b64_tr_b16 v[164:165], v12 offset:6144
  ds_read_b64_tr_b16 v[166:167], v12 offset:6912
  v_mfma_f32_16x16x32_bf16 v[52:55], v[144:147], v[188:191], v[52:55]
  ds_read_b64_tr_b16 v[168:169], v14 offset:6144
  s_add_u32 m0, s57, 28672
  s_add_u32 s52, s52, 196608
  buffer_load_dwordx4 v4, s[28:31], s52 offen lds
  v_mfma_f32_16x16x32_bf16 v[56:59], v[144:147], v[192:195], v[56:59]
  ds_read_b64_tr_b16 v[170:171], v14 offset:6912
  s_waitcnt lgkmcnt(10)
  v_mfma_f32_16x16x32_bf16 v[60:63], v[148:151], v[188:191], v[60:63]
  ds_read_b64_tr_b16 v[172:173], v12 offset:6208
  v_mfma_f32_16x16x32_bf16 v[64:67], v[148:151], v[192:195], v[64:67]
  ds_read_b64_tr_b16 v[174:175], v12 offset:6976
  buffer_load_dwordx4 v5, s[28:31], s52 offen offset:1024 lds
  v_mfma_f32_16x16x32_bf16 v[68:71], v[152:155], v[188:191], v[68:71]
  ds_read_b64_tr_b16 v[176:177], v14 offset:6208
  v_mfma_f32_16x16x32_bf16 v[72:75], v[152:155], v[192:195], v[72:75]
  ds_read_b64_tr_b16 v[178:179], v14 offset:6976
  s_waitcnt lgkmcnt(10)
  v_mfma_f32_16x16x32_bf16 v[76:79], v[156:159], v[188:191], v[76:79]
  ds_read_b64_tr_b16 v[180:181], v12 offset:6272
  buffer_load_dwordx4 v6, s[28:31], s52 offen offset:2048 lds
  v_mfma_f32_16x16x32_bf16 v[80:83], v[156:159], v[192:195], v[80:83]
  ds_read_b64_tr_b16 v[182:183], v12 offset:7040
  v_mfma_f32_16x16x32_bf16 v[84:87], v[160:163], v[188:191], v[84:87]
  ds_read_b64_tr_b16 v[184:185], v14 offset:6272
  v_mfma_f32_16x16x32_bf16 v[88:91], v[160:163], v[192:195], v[88:91]
  ds_read_b64_tr_b16 v[186:187], v14 offset:7040
  s_cmp_eq_u32 s5, 0
  s_cbranch_scc0 L_cs12
  v_mfma_f32_16x16x32_bf16 v[92:95], v[140:143], v[20:23], v[92:95]
  v_mfma_f32_16x16x32_bf16 v[96:99], v[144:147], v[20:23], v[96:99]
  v_mfma_f32_16x16x32_bf16 v[100:103], v[148:151], v[20:23], v[100:103]
  v_mfma_f32_16x16x32_bf16 v[104:107], v[152:155], v[20:23], v[104:107]
  v_mfma_f32_16x16x32_bf16 v[108:111], v[156:159], v[20:23], v[108:111]
  v_mfma_f32_16x16x32_bf16 v[112:115], v[160:163], v[20:23], v[112:115]
L_cs12:
  s_waitcnt lgkmcnt(0)
  s_waitcnt vmcnt(15)
  s_waitcnt vmcnt(14)
  s_cmp_lg_u32 s5, 0
  s_cbranch_scc1 L_ok1
L_chk1:
  v_cmp_ne_u32 vcc, s44, v248
  v_cmp_ne_u32 s[46:47], s45, v249
  s_nop 1
  s_or_b64 vcc, vcc, s[46:47]
  v_cmp_ne_u32 s[46:47], s44, v250
  s_nop 1
  s_or_b64 vcc, vcc, s[46:47]
  v_cmp_ne_u32 s[46:47], s45, v251
  s_nop 1
  s_or_b64 vcc, vcc, s[46:47]
  s_cbranch_scc0 L_ok1
  s_add_u32 s20, s20, 1
  s_cmp_gt_u32 s20, 0x40000
  s_cbranch_scc1 L_ok1
  s_sleep 2
  buffer_load_dwordx4 v[248:251], v19, s[36:39], 0 offen sc1
  s_waitcnt vmcnt(0)
  s_branch L_chk1
L_ok1:
  s_barrier
  v_mfma_f32_16x16x32_bf16 v[44:47], v[164:167], v[196:199], v[44:47]
  ds_read_b128 v[188:191], v8 offset:28672
  ds_read_b128 v[192:195], v8 offset:30720
  v_mfma_f32_16x16x32_bf16 v[48:51], v[164:167], v[200:203], v[48:51]
  ds_read_b64_tr_b16 v[140:141], v12 offset:28672
  ds_read_b64_tr_b16 v[142:143], v12 offset:29440
  v_mfma_f32_16x16x32_bf16 v[52:55], v[168:171], v[196:199], v[52:55]
  ds_read_b64_tr_b16 v[144:145], v14 offset:28672
  buffer_load_dwordx4 v[36:39], v18, s[36:39], 0 offen offset:0 sc1
  buffer_load_dwordx4 v[40:43], v18, s[36:39], 0 offen offset:256 sc1
  v_mfma_f32_16x16x32_bf16 v[56:59], v[168:171], v[200:203], v[56:59]
  ds_read_b64_tr_b16 v[146:147], v14 offset:29440
  v_mfma_f32_16x16x32_bf16 v[60:63], v[172:175], v[196:199], v[60:63]
  ds_read_b64_tr_b16 v[148:149], v12 offset:28736
  v_mfma_f32_16x16x32_bf16 v[64:67], v[172:175], v[200:203], v[64:67]
  ds_read_b64_tr_b16 v[150:151], v12 offset:29504
  s_mul_i32 s21, s8, 5
  s_add_u32 s21, s21, s62
  buffer_load_dwordx4 a[0:3], v1, s[36:39], s21 offen offset:0
  v_mfma_f32_16x16x32_bf16 v[68:71], v[176:179], v[196:199], v[68:71]
  ds_read_b64_tr_b16 v[152:153], v14 offset:28736
  v_mfma_f32_16x16x32_bf16 v[72:75], v[176:179], v[200:203], v[72:75]
  ds_read_b64_tr_b16 v[154:155], v14 offset:29504
  v_mfma_f32_16x16x32_bf16 v[76:79], v[180:183], v[196:199], v[76:79]
  ds_read_b64_tr_b16 v[156:157], v12 offset:28800
  buffer_load_dwordx4 a[4:7], v1, s[36:39], s21 offen offset:1024
  v_mfma_f32_16x16x32_bf16 v[80:83], v[180:183], v[200:203], v[80:83]
  ds_read_b64_tr_b16 v[158:159], v12 offset:29568
  v_mfma_f32_16x16x32_bf16 v[84:87], v[184:187], v[196:199], v[84:87]
  ds_read_b64_tr_b16 v[160:161], v14 offset:28800
  v_mfma_f32_16x16x32_bf16 v[88:91], v[184:187], v[200:203], v[88:91]
  ds_read_b64_tr_b16 v[162:163], v14 offset:29568
  buffer_load_dwordx4 a[8:11], v1, s[36:39], s21 offen offset:2048
  s_cmp_eq_u32 s5, 1
  s_cbranch_scc0 L_cs13
  v_mfma_f32_16x16x32_bf16 v[92:95], v[164:167], v[20:23], v[92:95]
  v_mfma_f32_16x16x32_bf16 v[96:99], v[168:171], v[20:23], v[96:99]
  v_mfma_f32_16x16x32_bf16 v[100:103], v[172:175], v[20:23], v[100:103]
  v_mfma_f32_16x16x32_bf16 v[104:107], v[176:179], v[20:23], v[104:107]
  v_mfma_f32_16x16x32_bf16 v[108:111], v[180:183], v[20:23], v[108:111]
  v_mfma_f32_16x16x32_bf16 v[112:115], v[184:187], v[20:23], v[112:115]
L_cs13:
  s_waitcnt lgkmcnt(8)
  v_mfma_f32_16x16x32_bf16 v[44:47], v[140:143], v[188:191], v[44:47]
  ds_read_b128 v[196:199], v10 offset:28672
  ds_read_b128 v[200:203], v10 offset:30720
  v_mfma_f32_16x16x32_bf16 v[48:51], v[140:143], v[192:195], v[48:51]
  ds_read_b64_tr_b16 v[164:165], v12 offset:34816
  ds_read_b64_tr_b16 v[166:167], v12 offset:35584
  v_mfma_f32_16x16x32_bf16 v[52:55], v[144:147], v[188:191], v[52:55]
  ds_read_b64_tr_b16 v[168:169], v14 offset:34816
  buffer_load_dwordx4 a[12:15], v1, s[36:39], s21 offen offset:3072
  v_mfma_f32_16x16x32_bf16 v[56:59], v[144:147], v[192:195], v[56:59]
  ds_read_b64_tr_b16 v[170:171], v14 offset:35584
  s_waitcnt lgkmcnt(10)
  v_mfma_f32_16x16x32_bf16 v[60:63], v[148:151], v[188:191], v[60:63]
  ds_read_b64_tr_b16 v[172:173], v12 offset:34880
  v_mfma_f32_16x16x32_bf16 v[64:67], v[148:151], v[192:195], v[64:67]
  ds_read_b64_tr_b16 v[174:175], v12 offset:35648
  s_add_u32 s21, s21, 4096
  buffer_load_dwordx4 a[16:19], v1, s[36:39], s21 offen offset:0
  v_mfma_f32_16x16x32_bf16 v[68:71], v[152:155], v[188:191], v[68:71]
  ds_read_b64_tr_b16 v[176:177], v14 offset:34880
  v_mfma_f32_16x16x32_bf16 v[72:75], v[152:155], v[192:195], v[72:75]
  ds_read_b64_tr_b16 v[178:179], v14 offset:35648
  s_waitcnt lgkmcnt(10)
  v_mfma_f32_16x16x32_bf16 v[76:79], v[156:159], v[188:191], v[76:79]
  ds_read_b64_tr_b16 v[180:181], v12 offset:34944
  buffer_load_dwordx4 a[20:23], v1, s[36:39], s21 offen offset:1024
  v_mfma_f32_16x16x32_bf16 v[80:83], v[156:159], v[192:195], v[80:83]
  ds_read_b64_tr_b16 v[182:183], v12 offset:35712
  v_mfma_f32_16x16x32_bf16 v[84:87], v[160:163], v[188:191], v[84:87]
  ds_read_b64_tr_b16 v[184:185], v14 offset:34944
  v_mfma_f32_16x16x32_bf16 v[88:91], v[160:163], v[192:195], v[88:91]
  ds_read_b64_tr_b16 v[186:187], v14 offset:35712
  buffer_load_dwordx4 a[24:27], v1, s[36:39], s21 offen offset:2048
  s_cmp_eq_u32 s5, 2
  s_cbranch_scc0 L_cs14
  v_mfma_f32_16x16x32_bf16 v[92:95], v[140:143], v[20:23], v[92:95]
  v_mfma_f32_16x16x32_bf16 v[96:99], v[144:147], v[20:23], v[96:99]
  v_mfma_f32_16x16x32_bf16 v[100:103], v[148:151], v[20:23], v[100:103]
  v_mfma_f32_16x16x32_bf16 v[104:107], v[152:155], v[20:23], v[104:107]
  v_mfma_f32_16x16x32_bf16 v[108:111], v[156:159], v[20:23], v[108:111]
  v_mfma_f32_16x16x32_bf16 v[112:115], v[160:163], v[20:23], v[112:115]
L_cs14:
  buffer_load_dwordx4 a[28:31], v1, s[36:39], s21 offen offset:3072
  s_waitcnt lgkmcnt(0)
  s_waitcnt vmcnt(17)
  s_barrier
  v_mfma_f32_16x16x32_bf16 v[44:47], v[164:167], v[196:199], v[44:47]
  ds_read_b128 v[188:191], v7 offset:0
  ds_read_b128 v[192:195], v7 offset:2048
  v_mfma_f32_16x16x32_bf16 v[48:51], v[164:167], v[200:203], v[48:51]
  ds_read_b64_tr_b16 v[140:141], v11 offset:0
  ds_read_b64_tr_b16 v[142:143], v11 offset:768
  v_mfma_f32_16x16x32_bf16 v[52:55], v[168:171], v[196:199], v[52:55]
  ds_read_b64_tr_b16 v[144:145], v13 offset:0
  s_add_u32 s21, s21, 4096
  buffer_load_dwordx4 a[32:35], v1, s[36:39], s21 offen offset:0
  v_mfma_f32_16x16x32_bf16 v[56:59], v[168:171], v[200:203], v[56:59]
  ds_read_b64_tr_b16 v[146:147], v13 offset:768
  v_mfma_f32_16x16x32_bf16 v[60:63], v[172:175], v[196:199], v[60:63]
  ds_read_b64_tr_b16 v[148:149], v11 offset:64
  v_mfma_f32_16x16x32_bf16 v[64:67], v[172:175], v[200:203], v[64:67]
  ds_read_b64_tr_b16 v[150:151], v11 offset:832
  buffer_load_dwordx4 a[36:39], v1, s[36:39], s21 offen offset:1024
  v_mfma_f32_16x16x32_bf16 v[68:71], v[176:179], v[196:199], v[68:71]
  ds_read_b64_tr_b16 v[152:153], v13 offset:64
  v_mfma_f32_16x16x32_bf16 v[72:75], v[176:179], v[200:203], v[72:75]
  ds_read_b64_tr_b16 v[154:155], v13 offset:832
  v_mfma_f32_16x16x32_bf16 v[76:79], v[180:183], v[196:199], v[76:79]
  ds_read_b64_tr_b16 v[156:157], v11 offset:128
  buffer_load_dwordx4 a[40:43], v1, s[36:39], s21 offen offset:2048
  v_mfma_f32_16x16x32_bf16 v[80:83], v[180:183], v[200:203], v[80:83]
  ds_read_b64_tr_b16 v[158:159], v11 offset:896
  v_mfma_f32_16x16x32_bf16 v[84:87], v[184:187], v[196:199], v[84:87]
  ds_read_b64_tr_b16 v[160:161], v13 offset:128
  v_mfma_f32_16x16x32_bf16 v[88:91], v[184:187], v[200:203], v[88:91]
  ds_read_b64_tr_b16 v[162:163], v13 offset:896
  buffer_load_dwordx4 a[44:47], v1, s[36:39], s21 offen offset:3072
  s_cmp_eq_u32 s5, 3
  s_cbranch_scc0 L_cs15
  v_mfma_f32_16x16x32_bf16 v[92:95], v[164:167], v[20:23], v[92:95]
  v_mfma_f32_16x16x32_bf16 v[96:99], v[168:171], v[20:23], v[96:99]
  v_mfma_f32_16x16x32_bf16 v[100:103], v[172:175], v[20:23], v[100:103]
  v_mfma_f32_16x16x32_bf16 v[104:107], v[176:179], v[20:23], v[104:107]
  v_mfma_f32_16x16x32_bf16 v[108:111], v[180:183], v[20:23], v[108:111]
  v_mfma_f32_16x16x32_bf16 v[112:115], v[184:187], v[20:23], v[112:115]
L_cs15:
  s_waitcnt lgkmcnt(8)
  v_mfma_f32_16x16x32_bf16 v[44:47], v[140:143], v[188:191], v[44:47]
  ds_read_b128 v[196:199], v9 offset:0
  ds_read_b128 v[200:203], v9 offset:2048
  v_mfma_f32_16x16x32_bf16 v[48:51], v[140:143], v[192:195], v[48:51]
  ds_read_b64_tr_b16 v[164:165], v11 offset:6144
  ds_read_b64_tr_b16 v[166:167], v11 offset:6912
  v_mfma_f32_16x16x32_bf16 v[52:55], v[144:147], v[188:191], v[52:55]
  ds_read_b64_tr_b16 v[168:169], v13 offset:6144
  s_add_u32 s21, s21, 4096
  buffer_load_dwordx4 a[48:51], v1, s[36:39], s21 offen offset:0
  v_mfma_f32_16x16x32_bf16 v[56:59], v[144:147], v[192:195], v[56:59]
  ds_read_b64_tr_b16 v[170:171], v13 offset:6912
  s_waitcnt lgkmcnt(10)
  v_mfma_f32_16x16x32_bf16 v[60:63], v[148:151], v[188:191], v[60:63]
  ds_read_b64_tr_b16 v[172:173], v11 offset:6208
  v_mfma_f32_16x16x32_bf16 v[64:67], v[148:151], v[192:195], v[64:67]
  ds_read_b64_tr_b16 v[174:175], v11 offset:6976
  buffer_load_dwordx4 a[52:55], v1, s[36:39], s21 offen offset:1024
  v_mfma_f32_16x16x32_bf16 v[68:71], v[152:155], v[188:191], v[68:71]
  ds_read_b64_tr_b16 v[176:177], v13 offset:6208
  v_mfma_f32_16x16x32_bf16 v[72:75], v[152:155], v[192:195], v[72:75]
  ds_read_b64_tr_b16 v[178:179], v13 offset:6976
  s_waitcnt lgkmcnt(10)
  v_mfma_f32_16x16x32_bf16 v[76:79], v[156:159], v[188:191], v[76:79]
  ds_read_b64_tr_b16 v[180:181], v11 offset:6272
  buffer_load_dwordx4 a[56:59], v1, s[36:39], s21 offen offset:2048
  v_mfma_f32_16x16x32_bf16 v[80:83], v[156:159], v[192:195], v[80:83]
  ds_read_b64_tr_b16 v[182:183], v11 offset:7040
  v_mfma_f32_16x16x32_bf16 v[84:87], v[160:163], v[188:191], v[84:87]
  ds_read_b64_tr_b16 v[184:185], v13 offset:6272
  v_mfma_f32_16x16x32_bf16 v[88:91], v[160:163], v[192:195], v[88:91]
  ds_read_b64_tr_b16 v[186:187], v13 offset:7040
  s_mul_i32 s21, s9, 5
  s_add_u32 s21, s21, s62
  buffer_load_dwordx4 a[60:63], v1, s[36:39], s21 offen offset:0
  s_cmp_eq_u32 s5, 0
  s_cbranch_scc0 L_cs16
  v_mfma_f32_16x16x32_bf16 v[92:95], v[140:143], v[20:23], v[92:95]
  v_mfma_f32_16x16x32_bf16 v[96:99], v[144:147], v[20:23], v[96:99]
  v_mfma_f32_16x16x32_bf16 v[100:103], v[148:151], v[20:23], v[100:103]
  v_mfma_f32_16x16x32_bf16 v[104:107], v[152:155], v[20:23], v[104:107]
  v_mfma_f32_16x16x32_bf16 v[108:111], v[156:159], v[20:23], v[108:111]
  v_mfma_f32_16x16x32_bf16 v[112:115], v[160:163], v[20:23], v[112:115]
L_cs16:
  v_lshrrev_b32 v229, 4, v0
  s_mul_i32 s53, s5, 384
  s_add_u32 s53, s53, 122880
  v_lshlrev_b32 v229, 4, v229
  v_add_u32 v230, s53, v229
  v_and_b32 v228, 15, v0
  v_cmp_eq_u32 vcc, 0, v228
  s_nop 1
  s_and_saveexec_b64 s[46:47], vcc
  ds_write_b128 v230, v[92:95] offset:0
  s_waitcnt lgkmcnt(14)
  ds_write_b128 v230, v[96:99] offset:64
  s_waitcnt lgkmcnt(14)
  ds_write_b128 v230, v[100:103] offset:128
  s_waitcnt lgkmcnt(14)
  ds_write_b128 v230, v[104:107] offset:192
  s_waitcnt lgkmcnt(14)
  ds_write_b128 v230, v[108:111] offset:256
  s_waitcnt lgkmcnt(14)
  ds_write_b128 v230, v[112:115] offset:320
  s_mov_b64 exec, s[46:47]
  v_min_u32 v228, 5, v228
  v_lshlrev_b32 v228, 6, v228
  v_add_u32 v228, v228, v229
  v_add_u32 v228, 122880, v228
  v_add_u32 v229, 1536, v230
  s_sub_u32 s53, s53, 121344
  v_add_u32 v230, s53, v228
  s_waitcnt lgkmcnt(0)
  s_waitcnt vmcnt(18)
  s_barrier
  v_mfma_f32_16x16x32_bf16 v[44:47], v[164:167], v[196:199], v[44:47]
  ds_read_b128 v[188:191], v7 offset:28672
  ds_read_b128 v[192:195], v7 offset:30720
  ds_read_b128 v[232:235], v228 offset:0
  ds_read_b128 v[236:239], v228 offset:384
  ds_read_b128 v[240:243], v228 offset:768
  ds_read_b128 v[244:247], v228 offset:1152
  v_mfma_f32_16x16x32_bf16 v[48:51], v[164:167], v[200:203], v[48:51]
  ds_read_b64_tr_b16 v[140:141], v11 offset:28672
  ds_read_b64_tr_b16 v[142:143], v11 offset:29440
  v_mfma_f32_16x16x32_bf16 v[52:55], v[168:171], v[196:199], v[52:55]
  ds_read_b64_tr_b16 v[144:145], v13 offset:28672
  buffer_load_dwordx4 a[64:67], v1, s[36:39], s21 offen offset:1024
  v_mfma_f32_16x16x32_bf16 v[56:59], v[168:171], v[200:203], v[56:59]
  ds_read_b64_tr_b16 v[146:147], v13 offset:29440
  v_mfma_f32_16x16x32_bf16 v[60:63], v[172:175], v[196:199], v[60:63]
  ds_read_b64_tr_b16 v[148:149], v11 offset:28736
  v_mfma_f32_16x16x32_bf16 v[64:67], v[172:175], v[200:203], v[64:67]
  ds_read_b64_tr_b16 v[150:151], v11 offset:29504
  buffer_load_dwordx4 a[68:71], v1, s[36:39], s21 offen offset:2048
  v_mfma_f32_16x16x32_bf16 v[68:71], v[176:179], v[196:199], v[68:71]
  ds_read_b64_tr_b16 v[152:153], v13 offset:28736
  v_mfma_f32_16x16x32_bf16 v[72:75], v[176:179], v[200:203], v[72:75]
  ds_read_b64_tr_b16 v[154:155], v13 offset:29504
  v_mfma_f32_16x16x32_bf16 v[76:79], v[180:183], v[196:199], v[76:79]
  ds_read_b64_tr_b16 v[156:157], v11 offset:28800
  buffer_load_dwordx4 a[72:75], v1, s[36:39], s21 offen offset:3072
  v_mfma_f32_16x16x32_bf16 v[80:83], v[180:183], v[200:203], v[80:83]
  s_waitcnt lgkmcnt(14)
  ds_read_b64_tr_b16 v[158:159], v11 offset:29568
  v_mfma_f32_16x16x32_bf16 v[84:87], v[184:187], v[196:199], v[84:87]
  s_waitcnt lgkmcnt(14)
  ds_read_b64_tr_b16 v[160:161], v13 offset:28800
  v_mfma_f32_16x16x32_bf16 v[88:91], v[184:187], v[200:203], v[88:91]
  s_waitcnt lgkmcnt(14)
  ds_read_b64_tr_b16 v[162:163], v13 offset:29568
  s_add_u32 s21, s21, 4096
  buffer_load_dwordx4 a[76:79], v1, s[36:39], s21 offen offset:0
  v_mfma_f32_16x16x32_bf16 v[116:119], v[164:167], v[20:23], 0
  v_mfma_f32_16x16x32_bf16 v[120:123], v[168:171], v[20:23], 0
  v_mfma_f32_16x16x32_bf16 v[124:127], v[172:175], v[20:23], 0
  v_mfma_f32_16x16x32_bf16 v[128:131], v[176:179], v[20:23], 0
  v_mfma_f32_16x16x32_bf16 v[132:135], v[180:183], v[20:23], 0
  v_mfma_f32_16x16x32_bf16 v[136:139], v[184:187], v[20:23], 0
  s_waitcnt lgkmcnt(8)
  v_mfma_f32_16x16x32_bf16 v[44:47], v[140:143], v[188:191], v[44:47]
  ds_read_b128 v[196:199], v9 offset:28672
  ds_read_b128 v[200:203], v9 offset:30720
  v_mfma_f32_16x16x32_bf16 v[48:51], v[140:143], v[192:195], v[48:51]
  ds_read_b64_tr_b16 v[164:165], v11 offset:34816
  ds_read_b64_tr_b16 v[166:167], v11 offset:35584
  v_add_f32 v232, v232, v236
  v_mfma_f32_16x16x32_bf16 v[52:55], v[144:147], v[188:191], v[52:55]
  ds_read_b64_tr_b16 v[168:169], v13 offset:34816
  buffer_load_dwordx4 a[80:83], v1, s[36:39], s21 offen offset:1024
  v_mfma_f32_16x16x32_bf16 v[56:59], v[144:147], v[192:195], v[56:59]
  ds_read_b64_tr_b16 v[170:171], v13 offset:35584
  v_add_f32 v233, v233, v237
  s_waitcnt lgkmcnt(10)
  v_mfma_f32_16x16x32_bf16 v[60:63], v[148:151], v[188:191], v[60:63]
  ds_read_b64_tr_b16 v[172:173], v11 offset:34880
  v_add_f32 v234, v234, v238
  v_mfma_f32_16x16x32_bf16 v[64:67], v[148:151], v[192:195], v[64:67]
  ds_read_b64_tr_b16 v[174:175], v11 offset:35648
  buffer_load_dwordx4 a[84:87], v1, s[36:39], s21 offen offset:2048
  v_mfma_f32_16x16x32_bf16 v[68:71], v[152:155], v[188:191], v[68:71]
  ds_read_b64_tr_b16 v[176:177], v13 offset:34880
  v_add_f32 v235, v235, v239
  v_mfma_f32_16x16x32_bf16 v[72:75], v[152:155], v[192:195], v[72:75]
  ds_read_b64_tr_b16 v[178:179], v13 offset:35648
  v_add_f32 v240, v240, v244
  s_waitcnt lgkmcnt(10)
  v_mfma_f32_16x16x32_bf16 v[76:79], v[156:159], v[188:191], v[76:79]
  ds_read_b64_tr_b16 v[180:181], v11 offset:34944
  buffer_load_dwordx4 a[88:91], v1, s[36:39], s21 offen offset:3072
  v_mfma_f32_16x16x32_bf16 v[80:83], v[156:159], v[192:195], v[80:83]
  ds_read_b64_tr_b16 v[182:183], v11 offset:35712
  v_add_f32 v241, v241, v245
  v_mfma_f32_16x16x32_bf16 v[84:87], v[160:163], v[188:191], v[84:87]
  ds_read_b64_tr_b16 v[184:185], v13 offset:34944
  v_add_f32 v242, v242, v246
  v_mfma_f32_16x16x32_bf16 v[88:91], v[160:163], v[192:195], v[88:91]
  ds_read_b64_tr_b16 v[186:187], v13 offset:35712
  s_add_u32 s21, s21, 4096
  buffer_load_dwordx4 a[92:95], v1, s[36:39], s21 offen offset:0
  v_mfma_f32_16x16x32_bf16 v[116:119], v[140:143], v[20:23], v[116:119]
  v_add_f32 v243, v243, v247
  v_add_f32 v232, v232, v240
  v_mfma_f32_16x16x32_bf16 v[120:123], v[144:147], v[20:23], v[120:123]
  v_add_f32 v233, v233, v241
  v_add_f32 v234, v234, v242
  v_mfma_f32_16x16x32_bf16 v[124:127], v[148:151], v[20:23], v[124:127]
  v_add_f32 v235, v235, v243
  ds_write_b128 v230, v[232:235]
  v_mfma_f32_16x16x32_bf16 v[128:131], v[152:155], v[20:23], v[128:131]
  v_mfma_f32_16x16x32_bf16 v[132:135], v[156:159], v[20:23], v[132:135]
  v_mfma_f32_16x16x32_bf16 v[136:139], v[160:163], v[20:23], v[136:139]
  s_waitcnt lgkmcnt(9)
  v_mfma_f32_16x16x32_bf16 v[44:47], v[164:167], v[196:199], v[44:47]
  s_waitcnt lgkmcnt(0)
  ds_read_b128 v[92:95], v229 offset:0
  ds_read_b128 v[96:99], v229 offset:64
  ds_read_b128 v[100:103], v229 offset:128
  ds_read_b128 v[104:107], v229 offset:192
  ds_read_b128 v[108:111], v229 offset:256
  ds_read_b128 v[112:115], v229 offset:320
  v_mfma_f32_16x16x32_bf16 v[48:51], v[164:167], v[200:203], v[48:51]
  v_mfma_f32_16x16x32_bf16 v[52:55], v[168:171], v[196:199], v[52:55]
  v_mfma_f32_16x16x32_bf16 v[56:59], v[168:171], v[200:203], v[56:59]
  v_mfma_f32_16x16x32_bf16 v[60:63], v[172:175], v[196:199], v[60:63]
  v_mfma_f32_16x16x32_bf16 v[64:67], v[172:175], v[200:203], v[64:67]
  v_mfma_f32_16x16x32_bf16 v[68:71], v[176:179], v[196:199], v[68:71]
  v_mfma_f32_16x16x32_bf16 v[72:75], v[176:179], v[200:203], v[72:75]
  v_mfma_f32_16x16x32_bf16 v[76:79], v[180:183], v[196:199], v[76:79]
  v_mfma_f32_16x16x32_bf16 v[80:83], v[180:183], v[200:203], v[80:83]
  v_mfma_f32_16x16x32_bf16 v[84:87], v[184:187], v[196:199], v[84:87]
  v_mfma_f32_16x16x32_bf16 v[88:91], v[184:187], v[200:203], v[88:91]
  v_mfma_f32_16x16x32_bf16 v[116:119], v[164:167], v[20:23], v[116:119]
  v_mfma_f32_16x16x32_bf16 v[120:123], v[168:171], v[20:23], v[120:123]
  v_mfma_f32_16x16x32_bf16 v[124:127], v[172:175], v[20:23], v[124:127]
  v_mfma_f32_16x16x32_bf16 v[128:131], v[176:179], v[20:23], v[128:131]
  v_mfma_f32_16x16x32_bf16 v[132:135], v[180:183], v[20:23], v[132:135]
  v_mfma_f32_16x16x32_bf16 v[136:139], v[184:187], v[20:23], v[136:139]
  s_barrier
  s_mov_b32 s58, 1.0
  s_mov_b32 s59, 1.0
  s_mov_b32 s60, 0xbdd2d3e8
  s_mov_b32 s61, 0xbdd2d3e8
  s_lshl_b32 s53, s3, 3
  s_lshl_b32 s54, s5, 1
  s_add_u32 s53, s53, s54
  s_mul_i32 s53, s53, 48
  s_mul_i32 s54, s4, 3
  s_add_u32 s53, s53, s54
  s_lshl_b32 s53, s53, 10
  s_add_u32 s54, s53, 49152
  s_waitcnt vmcnt(24)
L_chks:
  v_cmp_ne_u32 vcc, s44, v38
  v_cmp_ne_u32 s[46:47], s45, v39
  s_nop 1
  s_or_b64 vcc, vcc, s[46:47]
  v_cmp_ne_u32 s[46:47], s44, v42
  s_nop 1
  s_or_b64 vcc, vcc, s[46:47]
  v_cmp_ne_u32 s[46:47], s45, v43
  s_nop 1
  s_or_b64 vcc, vcc, s[46:47]
  s_cbranch_scc0 L_oks
  s_add_u32 s20, s20, 1
  s_cmp_gt_u32 s20, 0x40000
  s_cbranch_scc1 L_oks
  s_sleep 2
  buffer_load_dwordx4 v[36:39], v18, s[36:39], 0 offen offset:0 sc1
  buffer_load_dwordx4 v[40:43], v18, s[36:39], 0 offen offset:256 sc1
  s_waitcnt vmcnt(0)
  s_branch L_chks
L_oks:
  v_mov_b32 v20, 0xc0135761
  v_mov_b32 v21, 0xc0135761
  s_waitcnt lgkmcnt(0)
  v_pk_add_f32 v[92:93], v[92:93], v[116:117]
  v_pk_add_f32 v[94:95], v[94:95], v[118:119]
  v_pk_add_f32 v[96:97], v[96:97], v[120:121]
  v_pk_add_f32 v[98:99], v[98:99], v[122:123]
  v_pk_add_f32 v[100:101], v[100:101], v[124:125]
  v_pk_add_f32 v[102:103], v[102:103], v[126:127]
  v_pk_add_f32 v[104:105], v[104:105], v[128:129]
  v_pk_add_f32 v[106:107], v[106:107], v[130:131]
  v_pk_add_f32 v[108:109], v[108:109], v[132:133]
  v_pk_add_f32 v[110:111], v[110:111], v[134:135]
  v_pk_add_f32 v[112:113], v[112:113], v[136:137]
  v_pk_add_f32 v[114:115], v[114:115], v[138:139]
  v_pk_fma_f32 v[228:229], v[36:37], v[92:93], v[204:205] op_sel_hi:[0,1,1]
  v_pk_fma_f32 v[230:231], v[36:37], v[94:95], v[206:207] op_sel_hi:[0,1,1]
  v_pk_fma_f32 v[232:233], v[36:37], v[96:97], v[208:209] op_sel_hi:[0,1,1]
  v_pk_fma_f32 v[234:235], v[36:37], v[98:99], v[210:211] op_sel_hi:[0,1,1]
  v_pk_fma_f32 v[228:229], v[36:37], v[44:45], v[228:229] op_sel:[1,0,0] op_sel_hi:[1,1,1]
  v_pk_fma_f32 v[230:231], v[36:37], v[46:47], v[230:231] op_sel:[1,0,0] op_sel_hi:[1,1,1]
  v_pk_fma_f32 v[232:233], v[36:37], v[52:53], v[232:233] op_sel:[1,0,0] op_sel_hi:[1,1,1]
  v_pk_fma_f32 v[234:235], v[36:37], v[54:55], v[234:235] op_sel:[1,0,0] op_sel_hi:[1,1,1]
  v_pk_mul_f32 v[236:237], v[228:229], v[228:229]
  v_pk_mul_f32 v[238:239], v[230:231], v[230:231]
  v_pk_mul_f32 v[240:241], v[232:233], v[232:233]
  v_pk_mul_f32 v[242:243], v[234:235], v[234:235]
  v_pk_fma_f32 v[236:237], v[236:237], s[60:61], v[20:21]
  v_pk_fma_f32 v[238:239], v[238:239], s[60:61], v[20:21]
  v_pk_fma_f32 v[240:241], v[240:241], s[60:61], v[20:21]
  v_pk_fma_f32 v[242:243], v[242:243], s[60:61], v[20:21]
  v_pk_mul_f32 v[236:237], v[236:237], v[228:229]
  v_pk_mul_f32 v[238:239], v[238:239], v[230:231]
  v_pk_mul_f32 v[240:241], v[240:241], v[232:233]
  v_pk_mul_f32 v[242:243], v[242:243], v[234:235]
  v_exp_f32 v236, v236
  v_exp_f32 v237, v237
  v_exp_f32 v238, v238
  v_exp_f32 v239, v239
  v_exp_f32 v240, v240
  v_exp_f32 v241, v241
  v_exp_f32 v242, v242
  v_exp_f32 v243, v243
  v_pk_add_f32 v[236:237], v[236:237], s[58:59]
  v_pk_add_f32 v[238:239], v[238:239], s[58:59]
  v_pk_add_f32 v[240:241], v[240:241], s[58:59]
  v_pk_add_f32 v[242:243], v[242:243], s[58:59]
  v_rcp_f32 v236, v236
  v_rcp_f32 v237, v237
  v_rcp_f32 v238, v238
  v_rcp_f32 v239, v239
  v_rcp_f32 v240, v240
  v_rcp_f32 v241, v241
  v_rcp_f32 v242, v242
  v_rcp_f32 v243, v243
  v_pk_mul_f32 v[228:229], v[228:229], v[236:237]
  v_pk_mul_f32 v[230:231], v[230:231], v[238:239]
  v_pk_mul_f32 v[232:233], v[232:233], v[240:241]
  v_pk_mul_f32 v[234:235], v[234:235], v[242:243]
  v_cvt_pk_bf16_f32 v164, v228, v229
  v_cvt_pk_bf16_f32 v165, v230, v231
  v_cvt_pk_bf16_f32 v166, v232, v233
  v_cvt_pk_bf16_f32 v167, v234, v235
  buffer_store_dwordx4 v[164:167], v1, s[36:39], s53 offen offset:0 sc1
  buffer_load_dwordx4 a[96:99], v1, s[36:39], s21 offen offset:1024
  buffer_load_dwordx4 a[100:103], v1, s[36:39], s21 offen offset:2048
  v_pk_fma_f32 v[228:229], v[36:37], v[100:101], v[212:213] op_sel_hi:[0,1,1]
  v_pk_fma_f32 v[230:231], v[36:37], v[102:103], v[214:215] op_sel_hi:[0,1,1]
  v_pk_fma_f32 v[232:233], v[36:37], v[104:105], v[216:217] op_sel_hi:[0,1,1]
  v_pk_fma_f32 v[234:235], v[36:37], v[106:107], v[218:219] op_sel_hi:[0,1,1]
  v_pk_fma_f32 v[228:229], v[36:37], v[60:61], v[228:229] op_sel:[1,0,0] op_sel_hi:[1,1,1]
  v_pk_fma_f32 v[230:231], v[36:37], v[62:63], v[230:231] op_sel:[1,0,0] op_sel_hi:[1,1,1]
  v_pk_fma_f32 v[232:233], v[36:37], v[68:69], v[232:233] op_sel:[1,0,0] op_sel_hi:[1,1,1]
  v_pk_fma_f32 v[234:235], v[36:37], v[70:71], v[234:235] op_sel:[1,0,0] op_sel_hi:[1,1,1]
  v_pk_mul_f32 v[236:237], v[228:229], v[228:229]
  v_pk_mul_f32 v[238:239], v[230:231], v[230:231]
  v_pk_mul_f32 v[240:241], v[232:233], v[232:233]
  v_pk_mul_f32 v[242:243], v[234:235], v[234:235]
  v_pk_fma_f32 v[236:237], v[236:237], s[60:61], v[20:21]
  v_pk_fma_f32 v[238:239], v[238:239], s[60:61], v[20:21]
  v_pk_fma_f32 v[240:241], v[240:241], s[60:61], v[20:21]
  v_pk_fma_f32 v[242:243], v[242:243], s[60:61], v[20:21]
  v_pk_mul_f32 v[236:237], v[236:237], v[228:229]
  v_pk_mul_f32 v[238:239], v[238:239], v[230:231]
  v_pk_mul_f32 v[240:241], v[240:241], v[232:233]
  v_pk_mul_f32 v[242:243], v[242:243], v[234:235]
  v_exp_f32 v236, v236
  v_exp_f32 v237, v237
  v_exp_f32 v238, v238
  v_exp_f32 v239, v239
  v_exp_f32 v240, v240
  v_exp_f32 v241, v241
  v_exp_f32 v242, v242
  v_exp_f32 v243, v243
  v_pk_add_f32 v[236:237], v[236:237], s[58:59]
  v_pk_add_f32 v[238:239], v[238:239], s[58:59]
  v_pk_add_f32 v[240:241], v[240:241], s[58:59]
  v_pk_add_f32 v[242:243], v[242:243], s[58:59]
  v_rcp_f32 v236, v236
  v_rcp_f32 v237, v237
  v_rcp_f32 v238, v238
  v_rcp_f32 v239, v239
  v_rcp_f32 v240, v240
  v_rcp_f32 v241, v241
  v_rcp_f32 v242, v242
  v_rcp_f32 v243, v243
  v_pk_mul_f32 v[228:229], v[228:229], v[236:237]
  v_pk_mul_f32 v[230:231], v[230:231], v[238:239]
  v_pk_mul_f32 v[232:233], v[232:233], v[240:241]
  v_pk_mul_f32 v[234:235], v[234:235], v[242:243]
  v_cvt_pk_bf16_f32 v168, v228, v229
  v_cvt_pk_bf16_f32 v169, v230, v231
  v_cvt_pk_bf16_f32 v170, v232, v233
  v_cvt_pk_bf16_f32 v171, v234, v235
  buffer_store_dwordx4 v[168:171], v1, s[36:39], s53 offen offset:1024 sc1
  buffer_load_dwordx4 a[104:107], v1, s[36:39], s21 offen offset:3072
  s_add_u32 s21, s21, 4096
  buffer_load_dwordx4 a[108:111], v1, s[36:39], s21 offen offset:0
  v_pk_fma_f32 v[228:229], v[36:37], v[108:109], v[220:221] op_sel_hi:[0,1,1]
  v_pk_fma_f32 v[230:231], v[36:37], v[110:111], v[222:223] op_sel_hi:[0,1,1]
  v_pk_fma_f32 v[232:233], v[36:37], v[112:113], v[224:225] op_sel_hi:[0,1,1]
  v_pk_fma_f32 v[234:235], v[36:37], v[114:115], v[226:227] op_sel_hi:[0,1,1]
  v_pk_fma_f32 v[228:229], v[36:37], v[76:77], v[228:229] op_sel:[1,0,0] op_sel_hi:[1,1,1]
  v_pk_fma_f32 v[230:231], v[36:37], v[78:79], v[230:231] op_sel:[1,0,0] op_sel_hi:[1,1,1]
  v_pk_fma_f32 v[232:233], v[36:37], v[84:85], v[232:233] op_sel:[1,0,0] op_sel_hi:[1,1,1]
  v_pk_fma_f32 v[234:235], v[36:37], v[86:87], v[234:235] op_sel:[1,0,0] op_sel_hi:[1,1,1]
  v_pk_mul_f32 v[236:237], v[228:229], v[228:229]
  v_pk_mul_f32 v[238:239], v[230:231], v[230:231]
  v_pk_mul_f32 v[240:241], v[232:233], v[232:233]
  v_pk_mul_f32 v[242:243], v[234:235], v[234:235]
  v_pk_fma_f32 v[236:237], v[236:237], s[60:61], v[20:21]
  v_pk_fma_f32 v[238:239], v[238:239], s[60:61], v[20:21]
  v_pk_fma_f32 v[240:241], v[240:241], s[60:61], v[20:21]
  v_pk_fma_f32 v[242:243], v[242:243], s[60:61], v[20:21]
  v_pk_mul_f32 v[236:237], v[236:237], v[228:229]
  v_pk_mul_f32 v[238:239], v[238:239], v[230:231]
  v_pk_mul_f32 v[240:241], v[240:241], v[232:233]
  v_pk_mul_f32 v[242:243], v[242:243], v[234:235]
  v_exp_f32 v236, v236
  v_exp_f32 v237, v237
  v_exp_f32 v238, v238
  v_exp_f32 v239, v239
  v_exp_f32 v240, v240
  v_exp_f32 v241, v241
  v_exp_f32 v242, v242
  v_exp_f32 v243, v243
  v_pk_add_f32 v[236:237], v[236:237], s[58:59]
  v_pk_add_f32 v[238:239], v[238:239], s[58:59]
  v_pk_add_f32 v[240:241], v[240:241], s[58:59]
  v_pk_add_f32 v[242:243], v[242:243], s[58:59]
  v_rcp_f32 v236, v236
  v_rcp_f32 v237, v237
  v_rcp_f32 v238, v238
  v_rcp_f32 v239, v239
  v_rcp_f32 v240, v240
  v_rcp_f32 v241, v241
  v_rcp_f32 v242, v242
  v_rcp_f32 v243, v243
  v_pk_mul_f32 v[228:229], v[228:229], v[236:237]
  v_pk_mul_f32 v[230:231], v[230:231], v[238:239]
  v_pk_mul_f32 v[232:233], v[232:233], v[240:241]
  v_pk_mul_f32 v[234:235], v[234:235], v[242:243]
  v_cvt_pk_bf16_f32 v172, v228, v229
  v_cvt_pk_bf16_f32 v173, v230, v231
  v_cvt_pk_bf16_f32 v174, v232, v233
  v_cvt_pk_bf16_f32 v175, v234, v235
  buffer_store_dwordx4 v[172:175], v1, s[36:39], s53 offen offset:2048 sc1
  buffer_load_dwordx4 a[112:115], v1, s[36:39], s21 offen offset:1024
  buffer_load_dwordx4 a[116:119], v1, s[36:39], s21 offen offset:2048
  v_pk_fma_f32 v[228:229], v[40:41], v[92:93], v[204:205] op_sel_hi:[0,1,1]
  v_pk_fma_f32 v[230:231], v[40:41], v[94:95], v[206:207] op_sel_hi:[0,1,1]
  v_pk_fma_f32 v[232:233], v[40:41], v[96:97], v[208:209] op_sel_hi:[0,1,1]
  v_pk_fma_f32 v[234:235], v[40:41], v[98:99], v[210:211] op_sel_hi:[0,1,1]
  v_pk_fma_f32 v[228:229], v[40:41], v[48:49], v[228:229] op_sel:[1,0,0] op_sel_hi:[1,1,1]
  v_pk_fma_f32 v[230:231], v[40:41], v[50:51], v[230:231] op_sel:[1,0,0] op_sel_hi:[1,1,1]
  v_pk_fma_f32 v[232:233], v[40:41], v[56:57], v[232:233] op_sel:[1,0,0] op_sel_hi:[1,1,1]
  v_pk_fma_f32 v[234:235], v[40:41], v[58:59], v[234:235] op_sel:[1,0,0] op_sel_hi:[1,1,1]
  v_pk_mul_f32 v[236:237], v[228:229], v[228:229]
  v_pk_mul_f32 v[238:239], v[230:231], v[230:231]
  v_pk_mul_f32 v[240:241], v[232:233], v[232:233]
  v_pk_mul_f32 v[242:243], v[234:235], v[234:235]
  v_pk_fma_f32 v[236:237], v[236:237], s[60:61], v[20:21]
  v_pk_fma_f32 v[238:239], v[238:239], s[60:61], v[20:21]
  v_pk_fma_f32 v[240:241], v[240:241], s[60:61], v[20:21]
  v_pk_fma_f32 v[242:243], v[242:243], s[60:61], v[20:21]
  v_pk_mul_f32 v[236:237], v[236:237], v[228:229]
  v_pk_mul_f32 v[238:239], v[238:239], v[230:231]
  v_pk_mul_f32 v[240:241], v[240:241], v[232:233]
  v_pk_mul_f32 v[242:243], v[242:243], v[234:235]
  v_exp_f32 v236, v236
  v_exp_f32 v237, v237
  v_exp_f32 v238, v238
  v_exp_f32 v239, v239
  v_exp_f32 v240, v240
  v_exp_f32 v241, v241
  v_exp_f32 v242, v242
  v_exp_f32 v243, v243
  v_pk_add_f32 v[236:237], v[236:237], s[58:59]
  v_pk_add_f32 v[238:239], v[238:239], s[58:59]
  v_pk_add_f32 v[240:241], v[240:241], s[58:59]
  v_pk_add_f32 v[242:243], v[242:243], s[58:59]
  v_rcp_f32 v236, v236
  v_rcp_f32 v237, v237
  v_rcp_f32 v238, v238
  v_rcp_f32 v239, v239
  v_rcp_f32 v240, v240
  v_rcp_f32 v241, v241
  v_rcp_f32 v242, v242
  v_rcp_f32 v243, v243
  v_pk_mul_f32 v[228:229], v[228:229], v[236:237]
  v_pk_mul_f32 v[230:231], v[230:231], v[238:239]
  v_pk_mul_f32 v[232:233], v[232:233], v[240:241]
  v_pk_mul_f32 v[234:235], v[234:235], v[242:243]
  v_cvt_pk_bf16_f32 v176, v228, v229
  v_cvt_pk_bf16_f32 v177, v230, v231
  v_cvt_pk_bf16_f32 v178, v232, v233
  v_cvt_pk_bf16_f32 v179, v234, v235
  buffer_store_dwordx4 v[176:179], v1, s[36:39], s54 offen offset:0 sc1
  v_pk_fma_f32 v[228:229], v[40:41], v[100:101], v[212:213] op_sel_hi:[0,1,1]
  v_pk_fma_f32 v[230:231], v[40:41], v[102:103], v[214:215] op_sel_hi:[0,1,1]
  v_pk_fma_f32 v[232:233], v[40:41], v[104:105], v[216:217] op_sel_hi:[0,1,1]
  v_pk_fma_f32 v[234:235], v[40:41], v[106:107], v[218:219] op_sel_hi:[0,1,1]
  v_pk_fma_f32 v[228:229], v[40:41], v[64:65], v[228:229] op_sel:[1,0,0] op_sel_hi:[1,1,1]
  v_pk_fma_f32 v[230:231], v[40:41], v[66:67], v[230:231] op_sel:[1,0,0] op_sel_hi:[1,1,1]
  v_pk_fma_f32 v[232:233], v[40:41], v[72:73], v[232:233] op_sel:[1,0,0] op_sel_hi:[1,1,1]
  v_pk_fma_f32 v[234:235], v[40:41], v[74:75], v[234:235] op_sel:[1,0,0] op_sel_hi:[1,1,1]
  v_pk_mul_f32 v[236:237], v[228:229], v[228:229]
  v_pk_mul_f32 v[238:239], v[230:231], v[230:231]
  v_pk_mul_f32 v[240:241], v[232:233], v[232:233]
  v_pk_mul_f32 v[242:243], v[234:235], v[234:235]
  v_pk_fma_f32 v[236:237], v[236:237], s[60:61], v[20:21]
  v_pk_fma_f32 v[238:239], v[238:239], s[60:61], v[20:21]
  v_pk_fma_f32 v[240:241], v[240:241], s[60:61], v[20:21]
  v_pk_fma_f32 v[242:243], v[242:243], s[60:61], v[20:21]
  v_pk_mul_f32 v[236:237], v[236:237], v[228:229]
  v_pk_mul_f32 v[238:239], v[238:239], v[230:231]
  v_pk_mul_f32 v[240:241], v[240:241], v[232:233]
  v_pk_mul_f32 v[242:243], v[242:243], v[234:235]
  v_exp_f32 v236, v236
  v_exp_f32 v237, v237
  v_exp_f32 v238, v238
  v_exp_f32 v239, v239
  v_exp_f32 v240, v240
  v_exp_f32 v241, v241
  v_exp_f32 v242, v242
  v_exp_f32 v243, v243
  v_pk_add_f32 v[236:237], v[236:237], s[58:59]
  v_pk_add_f32 v[238:239], v[238:239], s[58:59]
  v_pk_add_f32 v[240:241], v[240:241], s[58:59]
  v_pk_add_f32 v[242:243], v[242:243], s[58:59]
  v_rcp_f32 v236, v236
  v_rcp_f32 v237, v237
  v_rcp_f32 v238, v238
  v_rcp_f32 v239, v239
  v_rcp_f32 v240, v240
  v_rcp_f32 v241, v241
  v_rcp_f32 v242, v242
  v_rcp_f32 v243, v243
  v_pk_mul_f32 v[228:229], v[228:229], v[236:237]
  v_pk_mul_f32 v[230:231], v[230:231], v[238:239]
  v_pk_mul_f32 v[232:233], v[232:233], v[240:241]
  v_pk_mul_f32 v[234:235], v[234:235], v[242:243]
  v_cvt_pk_bf16_f32 v180, v228, v229
  v_cvt_pk_bf16_f32 v181, v230, v231
  v_cvt_pk_bf16_f32 v182, v232, v233
  v_cvt_pk_bf16_f32 v183, v234, v235
  buffer_store_dwordx4 v[180:183], v1, s[36:39], s54 offen offset:1024 sc1
  v_pk_fma_f32 v[228:229], v[40:41], v[108:109], v[220:221] op_sel_hi:[0,1,1]
  v_pk_fma_f32 v[230:231], v[40:41], v[110:111], v[222:223] op_sel_hi:[0,1,1]
  v_pk_fma_f32 v[232:233], v[40:41], v[112:113], v[224:225] op_sel_hi:[0,1,1]
  v_pk_fma_f32 v[234:235], v[40:41], v[114:115], v[226:227] op_sel_hi:[0,1,1]
  v_pk_fma_f32 v[228:229], v[40:41], v[80:81], v[228:229] op_sel:[1,0,0] op_sel_hi:[1,1,1]
  v_pk_fma_f32 v[230:231], v[40:41], v[82:83], v[230:231] op_sel:[1,0,0] op_sel_hi:[1,1,1]
  v_pk_fma_f32 v[232:233], v[40:41], v[88:89], v[232:233] op_sel:[1,0,0] op_sel_hi:[1,1,1]
  v_pk_fma_f32 v[234:235], v[40:41], v[90:91], v[234:235] op_sel:[1,0,0] op_sel_hi:[1,1,1]
  v_pk_mul_f32 v[236:237], v[228:229], v[228:229]
  v_pk_mul_f32 v[238:239], v[230:231], v[230:231]
  v_pk_mul_f32 v[240:241], v[232:233], v[232:233]
  v_pk_mul_f32 v[242:243], v[234:235], v[234:235]
  v_pk_fma_f32 v[236:237], v[236:237], s[60:61], v[20:21]
  v_pk_fma_f32 v[238:239], v[238:239], s[60:61], v[20:21]
  v_pk_fma_f32 v[240:241], v[240:241], s[60:61], v[20:21]
  v_pk_fma_f32 v[242:243], v[242:243], s[60:61], v[20:21]
  v_pk_mul_f32 v[236:237], v[236:237], v[228:229]
  v_pk_mul_f32 v[238:239], v[238:239], v[230:231]
  v_pk_mul_f32 v[240:241], v[240:241], v[232:233]
  v_pk_mul_f32 v[242:243], v[242:243], v[234:235]
  v_exp_f32 v236, v236
  v_exp_f32 v237, v237
  v_exp_f32 v238, v238
  v_exp_f32 v239, v239
  v_exp_f32 v240, v240
  v_exp_f32 v241, v241
  v_exp_f32 v242, v242
  v_exp_f32 v243, v243
  v_pk_add_f32 v[236:237], v[236:237], s[58:59]
  v_pk_add_f32 v[238:239], v[238:239], s[58:59]
  v_pk_add_f32 v[240:241], v[240:241], s[58:59]
  v_pk_add_f32 v[242:243], v[242:243], s[58:59]
  v_rcp_f32 v236, v236
  v_rcp_f32 v237, v237
  v_rcp_f32 v238, v238
  v_rcp_f32 v239, v239
  v_rcp_f32 v240, v240
  v_rcp_f32 v241, v241
  v_rcp_f32 v242, v242
  v_rcp_f32 v243, v243
  v_pk_mul_f32 v[228:229], v[228:229], v[236:237]
  v_pk_mul_f32 v[230:231], v[230:231], v[238:239]
  v_pk_mul_f32 v[232:233], v[232:233], v[240:241]
  v_pk_mul_f32 v[234:235], v[234:235], v[242:243]
  v_cvt_pk_bf16_f32 v184, v228, v229
  v_cvt_pk_bf16_f32 v185, v230, v231
  v_cvt_pk_bf16_f32 v186, v232, v233
  v_cvt_pk_bf16_f32 v187, v234, v235
  buffer_store_dwordx4 v[184:187], v1, s[36:39], s54 offen offset:2048 sc1
  s_barrier
  s_mul_i32 s21, s10, 5
  s_add_u32 s21, s21, s62
  buffer_load_dwordx4 a[120:123], v1, s[36:39], s21 offen offset:0
  buffer_load_dwordx4 a[124:127], v1, s[36:39], s21 offen offset:1024
  buffer_load_dwordx4 a[128:131], v1, s[36:39], s21 offen offset:2048
  buffer_load_dwordx4 a[132:135], v1, s[36:39], s21 offen offset:3072
  s_lshl_b32 s53, s3, 1
  s_add_u32 s53, s53, s6
  s_lshl_b32 s53, s53, 2
  s_add_u32 s53, s53, s5
  s_lshl_b32 s53, s53, 6
  s_add_u32 s53, s53, 8458240
  v_and_b32 v22, 7, v0
  v_lshlrev_b32 v22, 3, v22
  v_add_u32 v22, s53, v22
  s_lshl_b32 s53, s3, 7
  s_lshl_b32 s54, s6, 6
  s_add_u32 s53, s53, s54
  s_mul_i32 s53, s53, 1280
  s_mul_i32 s54, s7, 160
  s_add_u32 s53, s53, s54
  v_mov_b32 v205, 2147418112
  s_lshl_b32 s55, s5, 6
  s_add_u32 s55, s55, 0
  v_add_u32 v201, s55, v0
  v_cmp_gt_u32 vcc, 480, v201
  v_min_u32 v201, 479, v201
  v_mul_u32_u24 v202, 6554, v201
  v_lshrrev_b32 v202, 16, v202
  v_mul_u32_u24 v203, 10, v202
  v_sub_u32 v203, v201, v203
  v_lshrrev_b32 v204, 4, v202
  v_mul_u32_u24 v204, 16128, v204
  v_mul_u32_u24 v206, 336, v202
  v_add_u32 v204, v204, v206
  v_lshl_add_u32 v2, v203, 5, v204
  v_mul_u32_u24 v204, 1280, v202
  v_lshl_add_u32 v204, v203, 4, v204
  v_add_u32 v204, s53, v204
  v_cndmask_b32 v7, v205, v204, vcc
  v_lshlrev_b32 v56, 4, v203
  v_add_u32 v56, s54, v56
  s_lshl_b32 s55, s5, 6
  s_add_u32 s55, s55, 256
  v_add_u32 v201, s55, v0
  v_cmp_gt_u32 vcc, 480, v201
  v_min_u32 v201, 479, v201
  v_mul_u32_u24 v202, 6554, v201
  v_lshrrev_b32 v202, 16, v202
  v_mul_u32_u24 v203, 10, v202
  v_sub_u32 v203, v201, v203
  v_lshrrev_b32 v204, 4, v202
  v_mul_u32_u24 v204, 16128, v204
  v_mul_u32_u24 v206, 336, v202
  v_add_u32 v204, v204, v206
  v_lshl_add_u32 v3, v203, 5, v204
  v_mul_u32_u24 v204, 1280, v202
  v_lshl_add_u32 v204, v203, 4, v204
  v_add_u32 v204, s53, v204
  v_cndmask_b32 v8, v205, v204, vcc
  v_lshlrev_b32 v57, 4, v203
  v_add_u32 v57, s54, v57
  s_mul_i32 s55, s5, 40
  s_add_u32 s55, s55, 480
  v_cmp_gt_u32 vcc, 40, v0
  v_min_u32 v201, 39, v0
  v_add_u32 v201, s55, v201
  v_mul_u32_u24 v202, 6554, v201
  v_lshrrev_b32 v202, 16, v202
  v_mul_u32_u24 v203, 10, v202
  v_sub_u32 v203, v201, v203
  v_lshrrev_b32 v204, 4, v202
  v_mul_u32_u24 v204, 16128, v204
  v_mul_u32_u24 v206, 336, v202
  v_add_u32 v204, v204, v206
  v_lshl_add_u32 v4, v203, 5, v204
  v_mul_u32_u24 v204, 1280, v202
  v_lshl_add_u32 v204, v203, 4, v204
  v_add_u32 v204, s53, v204
  v_cndmask_b32 v9, v205, v204, vcc
  v_lshlrev_b32 v58, 4, v203
  v_add_u32 v58, s54, v58
  v_and_b32 v201, 15, v0
  v_lshrrev_b32 v202, 4, v0
  v_mul_u32_u24 v201, 336, v201
  v_lshl_add_u32 v201, v202, 4, v201
  s_mul_i32 s55, s5, 5376
  v_add_u32 v23, s55, v201
  s_lshl_b32 s53, s3, 3
  s_lshl_b32 s54, s6, 2
  s_add_u32 s53, s53, s54
  s_mul_i32 s53, s53, 48
  s_mul_i32 s54, s5, 12
  s_add_u32 s53, s53, s54
  s_lshl_b32 s53, s53, 10
  s_lshr_b32 s49, s7, 1
  s_mov_b32 s49, 0
  s_add_u32 s54, s49, 0
  s_and_b32 s54, s54, 3
  s_mul_i32 s14, s54, 49152
  s_add_u32 s14, s14, s53
  s_add_u32 s54, s49, 1
  s_and_b32 s54, s54, 3
  s_mul_i32 s15, s54, 49152
  s_add_u32 s15, s15, s53
  s_add_u32 s54, s49, 2
  s_and_b32 s54, s54, 3
  s_mul_i32 s18, s54, 49152
  s_add_u32 s18, s18, s53
  s_add_u32 s54, s49, 3
  s_and_b32 s54, s54, 3
  s_mul_i32 s19, s54, 49152
  s_add_u32 s19, s19, s53
  s_lshl_b32 s53, s2, 2
  s_add_u32 s53, s53, s5
  s_mov_b32 s54, 8454144
  s_cmp_eq_u32 s53, 3
  s_cselect_b32 s54, s54, 2147418112
  v_add_u32 v13, s54, v1
  v_mov_b32 v252, s44
  v_mov_b32 v253, s45
  s_waitcnt vmcnt(4)
  buffer_store_dwordx2 v[252:253], v15, s[36:39], 0 offen sc1
  s_barrier
  s_add_u32 s21, s21, 4096
  buffer_load_dwordx4 a[136:139], v1, s[36:39], s21 offen offset:0
  buffer_load_dwordx4 a[140:143], v1, s[36:39], s21 offen offset:1024
  buffer_load_dwordx4 a[144:147], v1, s[36:39], s21 offen offset:2048
  buffer_load_dwordx4 a[148:151], v1, s[36:39], s21 offen offset:3072
  s_add_u32 s21, s21, 4096
  buffer_load_dwordx4 a[152:155], v1, s[36:39], s21 offen offset:0
  buffer_load_dwordx4 a[156:159], v1, s[36:39], s21 offen offset:1024
  buffer_load_dwordx4 a[160:163], v1, s[36:39], s21 offen offset:2048
  buffer_load_dwordx4 a[164:167], v1, s[36:39], s21 offen offset:3072
  s_add_u32 s21, s21, 4096
  buffer_load_dwordx4 a[168:171], v1, s[36:39], s21 offen offset:0
  buffer_load_dwordx4 a[172:175], v1, s[36:39], s21 offen offset:1024
  buffer_load_dwordx4 a[176:179], v1, s[36:39], s21 offen offset:2048
  s_mul_i32 s21, s11, 5
  s_add_u32 s21, s21, s62
  buffer_load_dwordx4 a[180:183], v1, s[36:39], s21 offen offset:0
  buffer_load_dwordx4 a[184:187], v1, s[36:39], s21 offen offset:1024
  buffer_load_dwordx4 a[188:191], v1, s[36:39], s21 offen offset:2048
  buffer_load_dwordx4 a[192:195], v1, s[36:39], s21 offen offset:3072
  s_add_u32 s21, s21, 4096
  buffer_load_dwordx4 a[196:199], v1, s[36:39], s21 offen offset:0
  buffer_load_dwordx2 v[248:249], v22, s[36:39], 0 offen sc1
  buffer_load_dwordx4 a[200:203], v1, s[36:39], s21 offen offset:1024
  buffer_load_dwordx4 a[204:207], v1, s[36:39], s21 offen offset:2048
  buffer_load_dwordx4 a[208:211], v1, s[36:39], s21 offen offset:3072
  s_add_u32 s21, s21, 4096
  buffer_load_dwordx4 a[212:215], v1, s[36:39], s21 offen offset:0
  buffer_load_dwordx4 a[216:219], v1, s[36:39], s21 offen offset:1024
  buffer_load_dwordx4 a[220:223], v1, s[36:39], s21 offen offset:2048
  buffer_load_dwordx4 a[224:227], v1, s[36:39], s21 offen offset:3072
  s_add_u32 s21, s21, 4096
  buffer_load_dwordx4 a[228:231], v1, s[36:39], s21 offen offset:0
  buffer_load_dwordx4 a[232:235], v1, s[36:39], s21 offen offset:1024
  buffer_load_dwordx4 a[236:239], v1, s[36:39], s21 offen offset:2048
  s_waitcnt vmcnt(10)
L_chk2:
  v_cmp_ne_u32 vcc, s44, v248
  v_cmp_ne_u32 s[46:47], s45, v249
  s_nop 1
  s_or_b64 vcc, vcc, s[46:47]
  s_cbranch_scc0 L_ok2
  s_add_u32 s20, s20, 1
  s_cmp_gt_u32 s20, 0x40000
  s_cbranch_scc1 L_ok2
  s_sleep 2
  buffer_load_dwordx2 v[248:249], v22, s[36:39], 0 offen sc1
  s_waitcnt vmcnt(0)
  s_branch L_chk2
L_ok2:
  s_add_u32 s51, s14, s8
  buffer_load_dwordx4 v[64:67], v1, s[36:39], s51 offen offset:0
  buffer_load_dwordx4 v[68:71], v1, s[36:39], s51 offen offset:1024
  buffer_load_dwordx4 v[72:75], v1, s[36:39], s51 offen offset:2048
  s_add_u32 s51, s14, s9
  buffer_load_dwordx4 v[76:79], v1, s[36:39], s51 offen offset:0
  buffer_load_dwordx4 v[80:83], v1, s[36:39], s51 offen offset:1024
  buffer_load_dwordx4 v[84:87], v1, s[36:39], s51 offen offset:2048
  s_add_u32 s51, s14, s10
  buffer_load_dwordx4 v[88:91], v1, s[36:39], s51 offen offset:0
  buffer_load_dwordx4 v[92:95], v1, s[36:39], s51 offen offset:1024
  s_waitcnt vmcnt(7)
  v_mfma_f32_16x16x32_bf16 v[36:39], a[0:3], v[64:67], 0
  v_mfma_f32_16x16x32_bf16 v[40:43], a[4:7], v[64:67], 0
  buffer_load_dwordx4 v[96:99], v1, s[36:39], s51 offen offset:2048
  v_mfma_f32_16x16x32_bf16 v[44:47], a[8:11], v[64:67], 0
  v_mfma_f32_16x16x32_bf16 v[48:51], a[12:15], v[64:67], 0
  s_add_u32 s51, s14, s11
  buffer_load_dwordx4 v[100:103], v1, s[36:39], s51 offen offset:0
  v_mfma_f32_16x16x32_bf16 v[52:55], a[16:19], v[64:67], 0
  s_waitcnt vmcnt(8)
  v_mfma_f32_16x16x32_bf16 v[36:39], a[20:23], v[68:71], v[36:39]
  v_mfma_f32_16x16x32_bf16 v[40:43], a[24:27], v[68:71], v[40:43]
  buffer_load_dwordx4 v[104:107], v1, s[36:39], s51 offen offset:1024
  v_mfma_f32_16x16x32_bf16 v[44:47], a[28:31], v[68:71], v[44:47]
  v_mfma_f32_16x16x32_bf16 v[48:51], a[32:35], v[68:71], v[48:51]
  buffer_load_dwordx4 v[108:111], v1, s[36:39], s51 offen offset:2048
  v_mfma_f32_16x16x32_bf16 v[52:55], a[36:39], v[68:71], v[52:55]
  s_waitcnt vmcnt(9)
  v_mfma_f32_16x16x32_bf16 v[36:39], a[40:43], v[72:75], v[36:39]
  v_mfma_f32_16x16x32_bf16 v[40:43], a[44:47], v[72:75], v[40:43]
  s_add_u32 s51, s15, s8
  buffer_load_dwordx4 v[112:115], v1, s[36:39], s51 offen offset:0
  v_mfma_f32_16x16x32_bf16 v[44:47], a[48:51], v[72:75], v[44:47]
  v_mfma_f32_16x16x32_bf16 v[48:51], a[52:55], v[72:75], v[48:51]
  buffer_load_dwordx4 v[116:119], v1, s[36:39], s51 offen offset:1024
  v_mfma_f32_16x16x32_bf16 v[52:55], a[56:59], v[72:75], v[52:55]
  s_waitcnt vmcnt(10)
  v_mfma_f32_16x16x32_bf16 v[36:39], a[60:63], v[76:79], v[36:39]
  v_mfma_f32_16x16x32_bf16 v[40:43], a[64:67], v[76:79], v[40:43]
  buffer_load_dwordx4 v[120:123], v1, s[36:39], s51 offen offset:2048
  v_mfma_f32_16x16x32_bf16 v[44:47], a[68:71], v[76:79], v[44:47]
  v_mfma_f32_16x16x32_bf16 v[48:51], a[72:75], v[76:79], v[48:51]
  s_add_u32 s51, s15, s9
  buffer_load_dwordx4 v[124:127], v1, s[36:39], s51 offen offset:0
  v_mfma_f32_16x16x32_bf16 v[52:55], a[76:79], v[76:79], v[52:55]
  s_waitcnt vmcnt(11)
  v_mfma_f32_16x16x32_bf16 v[36:39], a[80:83], v[80:83], v[36:39]
  v_mfma_f32_16x16x32_bf16 v[40:43], a[84:87], v[80:83], v[40:43]
  buffer_load_dwordx4 v[128:131], v1, s[36:39], s51 offen offset:1024
  v_mfma_f32_16x16x32_bf16 v[44:47], a[88:91], v[80:83], v[44:47]
  v_mfma_f32_16x16x32_bf16 v[48:51], a[92:95], v[80:83], v[48:51]
  buffer_load_dwordx4 v[132:135], v1, s[36:39], s51 offen offset:2048
  v_mfma_f32_16x16x32_bf16 v[52:55], a[96:99], v[80:83], v[52:55]
  s_waitcnt vmcnt(12)
  v_mfma_f32_16x16x32_bf16 v[36:39], a[100:103], v[84:87], v[36:39]
  v_mfma_f32_16x16x32_bf16 v[40:43], a[104:107], v[84:87], v[40:43]
  s_add_u32 s51, s15, s10
  buffer_load_dwordx4 v[136:139], v1, s[36:39], s51 offen offset:0
  v_mfma_f32_16x16x32_bf16 v[44:47], a[108:111], v[84:87], v[44:47]
  v_mfma_f32_16x16x32_bf16 v[48:51], a[112:115], v[84:87], v[48:51]
  buffer_load_dwordx4 v[140:143], v1, s[36:39], s51 offen offset:1024
  v_mfma_f32_16x16x32_bf16 v[52:55], a[116:119], v[84:87], v[52:55]
  s_waitcnt vmcnt(13)
  v_mfma_f32_16x16x32_bf16 v[36:39], a[120:123], v[88:91], v[36:39]
  v_mfma_f32_16x16x32_bf16 v[40:43], a[124:127], v[88:91], v[40:43]
  buffer_load_dwordx4 v[144:147], v1, s[36:39], s51 offen offset:2048
  v_mfma_f32_16x16x32_bf16 v[44:47], a[128:131], v[88:91], v[44:47]
  v_mfma_f32_16x16x32_bf16 v[48:51], a[132:135], v[88:91], v[48:51]
  s_add_u32 s51, s15, s11
  buffer_load_dwordx4 v[148:151], v1, s[36:39], s51 offen offset:0
  v_mfma_f32_16x16x32_bf16 v[52:55], a[136:139], v[88:91], v[52:55]
  s_waitcnt vmcnt(14)
  v_mfma_f32_16x16x32_bf16 v[36:39], a[140:143], v[92:95], v[36:39]
  v_mfma_f32_16x16x32_bf16 v[40:43], a[144:147], v[92:95], v[40:43]
  buffer_load_dwordx4 v[152:155], v1, s[36:39], s51 offen offset:1024
  v_mfma_f32_16x16x32_bf16 v[44:47], a[148:151], v[92:95], v[44:47]
  v_mfma_f32_16x16x32_bf16 v[48:51], a[152:155], v[92:95], v[48:51]
  buffer_load_dwordx4 v[156:159], v1, s[36:39], s51 offen offset:2048
  v_mfma_f32_16x16x32_bf16 v[52:55], a[156:159], v[92:95], v[52:55]
  s_waitcnt vmcnt(15)
  v_mfma_f32_16x16x32_bf16 v[36:39], a[160:163], v[96:99], v[36:39]
  v_mfma_f32_16x16x32_bf16 v[40:43], a[164:167], v[96:99], v[40:43]
  global_load_dwordx4 v[24:27], v56, s[16:17]
  global_load_dwordx4 v[28:31], v57, s[16:17]
  global_load_dwordx4 v[32:35], v58, s[16:17]
  v_mfma_f32_16x16x32_bf16 v[44:47], a[168:171], v[96:99], v[44:47]
  v_mfma_f32_16x16x32_bf16 v[48:51], a[172:175], v[96:99], v[48:51]
  s_add_u32 s51, s18, s8
  buffer_load_dwordx4 v[160:163], v1, s[36:39], s51 offen offset:0
  v_mfma_f32_16x16x32_bf16 v[52:55], a[176:179], v[96:99], v[52:55]
  s_waitcnt vmcnt(18)
  v_mfma_f32_16x16x32_bf16 v[36:39], a[180:183], v[100:103], v[36:39]
  v_mfma_f32_16x16x32_bf16 v[40:43], a[184:187], v[100:103], v[40:43]
  buffer_load_dwordx4 v[164:167], v1, s[36:39], s51 offen offset:1024
  v_mfma_f32_16x16x32_bf16 v[44:47], a[188:191], v[100:103], v[44:47]
  v_mfma_f32_16x16x32_bf16 v[48:51], a[192:195], v[100:103], v[48:51]
  buffer_load_dwordx4 v[168:171], v1, s[36:39], s51 offen offset:2048
  v_mfma_f32_16x16x32_bf16 v[52:55], a[196:199], v[100:103], v[52:55]
  s_waitcnt vmcnt(19)
  v_mfma_f32_16x16x32_bf16 v[36:39], a[200:203], v[104:107], v[36:39]
  v_mfma_f32_16x16x32_bf16 v[40:43], a[204:207], v[104:107], v[40:43]
  s_add_u32 s51, s18, s9
  buffer_load_dwordx4 v[172:175], v1, s[36:39], s51 offen offset:0
  v_mfma_f32_16x16x32_bf16 v[44:47], a[208:211], v[104:107], v[44:47]
  v_mfma_f32_16x16x32_bf16 v[48:51], a[212:215], v[104:107], v[48:51]
  buffer_load_dwordx4 v[176:179], v1, s[36:39], s51 offen offset:1024
  v_mfma_f32_16x16x32_bf16 v[52:55], a[216:219], v[104:107], v[52:55]
  s_waitcnt vmcnt(20)
  v_mfma_f32_16x16x32_bf16 v[36:39], a[220:223], v[108:111], v[36:39]
  v_mfma_f32_16x16x32_bf16 v[40:43], a[224:227], v[108:111], v[40:43]
  buffer_load_dwordx4 v[180:183], v1, s[36:39], s51 offen offset:2048
  v_mfma_f32_16x16x32_bf16 v[44:47], a[228:231], v[108:111], v[44:47]
  v_mfma_f32_16x16x32_bf16 v[48:51], a[232:235], v[108:111], v[48:51]
  s_add_u32 s51, s18, s10
  buffer_load_dwordx4 v[184:187], v1, s[36:39], s51 offen offset:0
  v_mfma_f32_16x16x32_bf16 v[52:55], a[236:239], v[108:111], v[52:55]
  s_waitcnt vmcnt(21)
  v_mfma_f32_16x16x32_bf16 v[64:67], a[0:3], v[112:115], 0
  v_mfma_f32_16x16x32_bf16 v[68:71], a[4:7], v[112:115], 0
  buffer_load_dwordx4 v[188:191], v1, s[36:39], s51 offen offset:1024
  v_mfma_f32_16x16x32_bf16 v[72:75], a[8:11], v[112:115], 0
  v_mfma_f32_16x16x32_bf16 v[76:79], a[12:15], v[112:115], 0
  v_mfma_f32_16x16x32_bf16 v[80:83], a[16:19], v[112:115], 0
  s_waitcnt vmcnt(21)
  v_mfma_f32_16x16x32_bf16 v[64:67], a[20:23], v[116:119], v[64:67]
  v_mfma_f32_16x16x32_bf16 v[68:71], a[24:27], v[116:119], v[68:71]
  buffer_load_dwordx4 v[192:195], v1, s[36:39], s51 offen offset:2048
  v_mfma_f32_16x16x32_bf16 v[72:75], a[28:31], v[116:119], v[72:75]
  v_mfma_f32_16x16x32_bf16 v[76:79], a[32:35], v[116:119], v[76:79]
  v_mfma_f32_16x16x32_bf16 v[80:83], a[36:39], v[116:119], v[80:83]
  ds_write_b128 v23, v[36:39] offset:0
  ds_write_b128 v23, v[40:43] offset:64
  ds_write_b128 v23, v[44:47] offset:128
  ds_write_b128 v23, v[48:51] offset:192
  ds_write_b128 v23, v[52:55] offset:256
  s_waitcnt vmcnt(21)
  v_mfma_f32_16x16x32_bf16 v[64:67], a[40:43], v[120:123], v[64:67]
  v_mfma_f32_16x16x32_bf16 v[68:71], a[44:47], v[120:123], v[68:71]
  s_add_u32 s51, s18, s11
  buffer_load_dwordx4 v[196:199], v1, s[36:39], s51 offen offset:0
  v_mfma_f32_16x16x32_bf16 v[72:75], a[48:51], v[120:123], v[72:75]
  v_mfma_f32_16x16x32_bf16 v[76:79], a[52:55], v[120:123], v[76:79]
  v_mfma_f32_16x16x32_bf16 v[80:83], a[56:59], v[120:123], v[80:83]
  s_waitcnt vmcnt(21)
  v_mfma_f32_16x16x32_bf16 v[64:67], a[60:63], v[124:127], v[64:67]
  v_mfma_f32_16x16x32_bf16 v[68:71], a[64:67], v[124:127], v[68:71]
  buffer_load_dwordx4 v[200:203], v1, s[36:39], s51 offen offset:1024
  v_mfma_f32_16x16x32_bf16 v[72:75], a[68:71], v[124:127], v[72:75]
  v_mfma_f32_16x16x32_bf16 v[76:79], a[72:75], v[124:127], v[76:79]
  v_mfma_f32_16x16x32_bf16 v[80:83], a[76:79], v[124:127], v[80:83]
  s_waitcnt vmcnt(21)
  v_mfma_f32_16x16x32_bf16 v[64:67], a[80:83], v[128:131], v[64:67]
  v_mfma_f32_16x16x32_bf16 v[68:71], a[84:87], v[128:131], v[68:71]
  buffer_load_dwordx4 v[204:207], v1, s[36:39], s51 offen offset:2048
  v_mfma_f32_16x16x32_bf16 v[72:75], a[88:91], v[128:131], v[72:75]
  v_mfma_f32_16x16x32_bf16 v[76:79], a[92:95], v[128:131], v[76:79]
  v_mfma_f32_16x16x32_bf16 v[80:83], a[96:99], v[128:131], v[80:83]
  s_waitcnt vmcnt(21)
  v_mfma_f32_16x16x32_bf16 v[64:67], a[100:103], v[132:135], v[64:67]
  v_mfma_f32_16x16x32_bf16 v[68:71], a[104:107], v[132:135], v[68:71]
  s_add_u32 s51, s19, s8
  buffer_load_dwordx4 v[208:211], v1, s[36:39], s51 offen offset:0
  v_mfma_f32_16x16x32_bf16 v[72:75], a[108:111], v[132:135], v[72:75]
  v_mfma_f32_16x16x32_bf16 v[76:79], a[112:115], v[132:135], v[76:79]
  v_mfma_f32_16x16x32_bf16 v[80:83], a[116:119], v[132:135], v[80:83]
  s_waitcnt vmcnt(21)
  v_mfma_f32_16x16x32_bf16 v[64:67], a[120:123], v[136:139], v[64:67]
  v_mfma_f32_16x16x32_bf16 v[68:71], a[124:127], v[136:139], v[68:71]
  buffer_load_dwordx4 v[212:215], v1, s[36:39], s51 offen offset:1024
  v_mfma_f32_16x16x32_bf16 v[72:75], a[128:131], v[136:139], v[72:75]
  v_mfma_f32_16x16x32_bf16 v[76:79], a[132:135], v[136:139], v[76:79]
  v_mfma_f32_16x16x32_bf16 v[80:83], a[136:139], v[136:139], v[80:83]
  s_waitcnt vmcnt(21)
  v_mfma_f32_16x16x32_bf16 v[64:67], a[140:143], v[140:143], v[64:67]
  v_mfma_f32_16x16x32_bf16 v[68:71], a[144:147], v[140:143], v[68:71]
  buffer_load_dwordx4 v[216:219], v1, s[36:39], s51 offen offset:2048
  v_mfma_f32_16x16x32_bf16 v[72:75], a[148:151], v[140:143], v[72:75]
  v_mfma_f32_16x16x32_bf16 v[76:79], a[152:155], v[140:143], v[76:79]
  v_mfma_f32_16x16x32_bf16 v[80:83], a[156:159], v[140:143], v[80:83]
  s_waitcnt vmcnt(21)
  v_mfma_f32_16x16x32_bf16 v[64:67], a[160:163], v[144:147], v[64:67]
  v_mfma_f32_16x16x32_bf16 v[68:71], a[164:167], v[144:147], v[68:71]
  s_add_u32 s51, s19, s9
  buffer_load_dwordx4 v[220:223], v1, s[36:39], s51 offen offset:0
  v_mfma_f32_16x16x32_bf16 v[72:75], a[168:171], v[144:147], v[72:75]
  v_mfma_f32_16x16x32_bf16 v[76:79], a[172:175], v[144:147], v[76:79]
  v_mfma_f32_16x16x32_bf16 v[80:83], a[176:179], v[144:147], v[80:83]
  s_waitcnt vmcnt(21)
  v_mfma_f32_16x16x32_bf16 v[64:67], a[180:183], v[148:151], v[64:67]
  v_mfma_f32_16x16x32_bf16 v[68:71], a[184:187], v[148:151], v[68:71]
  buffer_load_dwordx4 v[224:227], v1, s[36:39], s51 offen offset:1024
  v_mfma_f32_16x16x32_bf16 v[72:75], a[188:191], v[148:151], v[72:75]
  v_mfma_f32_16x16x32_bf16 v[76:79], a[192:195], v[148:151], v[76:79]
  v_mfma_f32_16x16x32_bf16 v[80:83], a[196:199], v[148:151], v[80:83]
  s_waitcnt vmcnt(21)
  v_mfma_f32_16x16x32_bf16 v[64:67], a[200:203], v[152:155], v[64:67]
  v_mfma_f32_16x16x32_bf16 v[68:71], a[204:207], v[152:155], v[68:71]
  buffer_load_dwordx4 v[228:231], v1, s[36:39], s51 offen offset:2048
  v_mfma_f32_16x16x32_bf16 v[72:75], a[208:211], v[152:155], v[72:75]
  v_mfma_f32_16x16x32_bf16 v[76:79], a[212:215], v[152:155], v[76:79]
  v_mfma_f32_16x16x32_bf16 v[80:83], a[216:219], v[152:155], v[80:83]
  s_waitcnt vmcnt(21)
  v_mfma_f32_16x16x32_bf16 v[64:67], a[220:223], v[156:159], v[64:67]
  v_mfma_f32_16x16x32_bf16 v[68:71], a[224:227], v[156:159], v[68:71]
  s_add_u32 s51, s19, s10
  buffer_load_dwordx4 v[232:235], v1, s[36:39], s51 offen offset:0
  v_mfma_f32_16x16x32_bf16 v[72:75], a[228:231], v[156:159], v[72:75]
  v_mfma_f32_16x16x32_bf16 v[76:79], a[232:235], v[156:159], v[76:79]
  v_mfma_f32_16x16x32_bf16 v[80:83], a[236:239], v[156:159], v[80:83]
  s_waitcnt lgkmcnt(0)
  s_waitcnt vmcnt(18)
  v_mfma_f32_16x16x32_bf16 v[36:39], a[0:3], v[160:163], 0
  v_mfma_f32_16x16x32_bf16 v[40:43], a[4:7], v[160:163], 0
  buffer_load_dwordx4 v[236:239], v1, s[36:39], s51 offen offset:1024
  v_mfma_f32_16x16x32_bf16 v[44:47], a[8:11], v[160:163], 0
  v_mfma_f32_16x16x32_bf16 v[48:51], a[12:15], v[160:163], 0
  v_mfma_f32_16x16x32_bf16 v[52:55], a[16:19], v[160:163], 0
  s_waitcnt vmcnt(18)
  v_mfma_f32_16x16x32_bf16 v[36:39], a[20:23], v[164:167], v[36:39]
  v_mfma_f32_16x16x32_bf16 v[40:43], a[24:27], v[164:167], v[40:43]
  buffer_load_dwordx4 v[240:243], v1, s[36:39], s51 offen offset:2048
  v_mfma_f32_16x16x32_bf16 v[44:47], a[28:31], v[164:167], v[44:47]
  v_mfma_f32_16x16x32_bf16 v[48:51], a[32:35], v[164:167], v[48:51]
  v_mfma_f32_16x16x32_bf16 v[52:55], a[36:39], v[164:167], v[52:55]
  ds_write_b128 v23, v[64:67] offset:21504
  ds_write_b128 v23, v[68:71] offset:21568
  ds_write_b128 v23, v[72:75] offset:21632
  ds_write_b128 v23, v[76:79] offset:21696
  ds_write_b128 v23, v[80:83] offset:21760
  s_waitcnt vmcnt(18)
  v_mfma_f32_16x16x32_bf16 v[36:39], a[40:43], v[168:171], v[36:39]
  v_mfma_f32_16x16x32_bf16 v[40:43], a[44:47], v[168:171], v[40:43]
  s_add_u32 s51, s19, s11
  buffer_load_dwordx4 v[244:247], v1, s[36:39], s51 offen offset:0
  v_mfma_f32_16x16x32_bf16 v[44:47], a[48:51], v[168:171], v[44:47]
  v_mfma_f32_16x16x32_bf16 v[48:51], a[52:55], v[168:171], v[48:51]
  v_mfma_f32_16x16x32_bf16 v[52:55], a[56:59], v[168:171], v[52:55]
  s_waitcnt vmcnt(18)
  v_mfma_f32_16x16x32_bf16 v[36:39], a[60:63], v[172:175], v[36:39]
  v_mfma_f32_16x16x32_bf16 v[40:43], a[64:67], v[172:175], v[40:43]
  buffer_load_dwordx4 v[248:251], v1, s[36:39], s51 offen offset:1024
  v_mfma_f32_16x16x32_bf16 v[44:47], a[68:71], v[172:175], v[44:47]
  v_mfma_f32_16x16x32_bf16 v[48:51], a[72:75], v[172:175], v[48:51]
  v_mfma_f32_16x16x32_bf16 v[52:55], a[76:79], v[172:175], v[52:55]
  s_waitcnt vmcnt(18)
  v_mfma_f32_16x16x32_bf16 v[36:39], a[80:83], v[176:179], v[36:39]
  v_mfma_f32_16x16x32_bf16 v[40:43], a[84:87], v[176:179], v[40:43]
  buffer_load_dwordx4 v[252:255], v1, s[36:39], s51 offen offset:2048
  v_mfma_f32_16x16x32_bf16 v[44:47], a[88:91], v[176:179], v[44:47]
  v_mfma_f32_16x16x32_bf16 v[48:51], a[92:95], v[176:179], v[48:51]
  v_mfma_f32_16x16x32_bf16 v[52:55], a[96:99], v[176:179], v[52:55]
  s_waitcnt vmcnt(18)
  v_mfma_f32_16x16x32_bf16 v[36:39], a[100:103], v[180:183], v[36:39]
  v_mfma_f32_16x16x32_bf16 v[40:43], a[104:107], v[180:183], v[40:43]
  buffer_load_dwordx4 v[14:17], v13, s[36:39], 0 offen sc1
  buffer_load_dwordx4 v[18:21], v13, s[36:39], 0 offen offset:1024 sc1
  v_mfma_f32_16x16x32_bf16 v[44:47], a[108:111], v[180:183], v[44:47]
  v_mfma_f32_16x16x32_bf16 v[48:51], a[112:115], v[180:183], v[48:51]
  v_mfma_f32_16x16x32_bf16 v[52:55], a[116:119], v[180:183], v[52:55]
  s_waitcnt vmcnt(19)
  v_mfma_f32_16x16x32_bf16 v[36:39], a[120:123], v[184:187], v[36:39]
  v_mfma_f32_16x16x32_bf16 v[40:43], a[124:127], v[184:187], v[40:43]
  v_mfma_f32_16x16x32_bf16 v[44:47], a[128:131], v[184:187], v[44:47]
  v_mfma_f32_16x16x32_bf16 v[48:51], a[132:135], v[184:187], v[48:51]
  v_mfma_f32_16x16x32_bf16 v[52:55], a[136:139], v[184:187], v[52:55]
  s_waitcnt vmcnt(18)
  v_mfma_f32_16x16x32_bf16 v[36:39], a[140:143], v[188:191], v[36:39]
  v_mfma_f32_16x16x32_bf16 v[40:43], a[144:147], v[188:191], v[40:43]
  v_mfma_f32_16x16x32_bf16 v[44:47], a[148:151], v[188:191], v[44:47]
  v_mfma_f32_16x16x32_bf16 v[48:51], a[152:155], v[188:191], v[48:51]
  v_mfma_f32_16x16x32_bf16 v[52:55], a[156:159], v[188:191], v[52:55]
  s_waitcnt vmcnt(17)
  v_mfma_f32_16x16x32_bf16 v[36:39], a[160:163], v[192:195], v[36:39]
  v_mfma_f32_16x16x32_bf16 v[40:43], a[164:167], v[192:195], v[40:43]
  v_mfma_f32_16x16x32_bf16 v[44:47], a[168:171], v[192:195], v[44:47]
  v_mfma_f32_16x16x32_bf16 v[48:51], a[172:175], v[192:195], v[48:51]
  v_mfma_f32_16x16x32_bf16 v[52:55], a[176:179], v[192:195], v[52:55]
  s_waitcnt vmcnt(16)
  v_mfma_f32_16x16x32_bf16 v[36:39], a[180:183], v[196:199], v[36:39]
  v_mfma_f32_16x16x32_bf16 v[40:43], a[184:187], v[196:199], v[40:43]
  v_mfma_f32_16x16x32_bf16 v[44:47], a[188:191], v[196:199], v[44:47]
  v_mfma_f32_16x16x32_bf16 v[48:51], a[192:195], v[196:199], v[48:51]
  v_mfma_f32_16x16x32_bf16 v[52:55], a[196:199], v[196:199], v[52:55]
  s_waitcnt vmcnt(15)
  v_mfma_f32_16x16x32_bf16 v[36:39], a[200:203], v[200:203], v[36:39]
  v_mfma_f32_16x16x32_bf16 v[40:43], a[204:207], v[200:203], v[40:43]
  v_mfma_f32_16x16x32_bf16 v[44:47], a[208:211], v[200:203], v[44:47]
  v_mfma_f32_16x16x32_bf16 v[48:51], a[212:215], v[200:203], v[48:51]
  v_mfma_f32_16x16x32_bf16 v[52:55], a[216:219], v[200:203], v[52:55]
  s_waitcnt vmcnt(14)
  v_mfma_f32_16x16x32_bf16 v[36:39], a[220:223], v[204:207], v[36:39]
  v_mfma_f32_16x16x32_bf16 v[40:43], a[224:227], v[204:207], v[40:43]
  v_mfma_f32_16x16x32_bf16 v[44:47], a[228:231], v[204:207], v[44:47]
  v_mfma_f32_16x16x32_bf16 v[48:51], a[232:235], v[204:207], v[48:51]
  v_mfma_f32_16x16x32_bf16 v[52:55], a[236:239], v[204:207], v[52:55]
  s_waitcnt vmcnt(13)
  v_mfma_f32_16x16x32_bf16 v[160:163], a[0:3], v[208:211], 0
  v_mfma_f32_16x16x32_bf16 v[164:167], a[4:7], v[208:211], 0
  v_mfma_f32_16x16x32_bf16 v[168:171], a[8:11], v[208:211], 0
  v_mfma_f32_16x16x32_bf16 v[172:175], a[12:15], v[208:211], 0
  v_mfma_f32_16x16x32_bf16 v[176:179], a[16:19], v[208:211], 0
  s_waitcnt vmcnt(12)
  v_mfma_f32_16x16x32_bf16 v[160:163], a[20:23], v[212:215], v[160:163]
  v_mfma_f32_16x16x32_bf16 v[164:167], a[24:27], v[212:215], v[164:167]
  v_mfma_f32_16x16x32_bf16 v[168:171], a[28:31], v[212:215], v[168:171]
  v_mfma_f32_16x16x32_bf16 v[172:175], a[32:35], v[212:215], v[172:175]
  v_mfma_f32_16x16x32_bf16 v[176:179], a[36:39], v[212:215], v[176:179]
  ds_write_b128 v23, v[36:39] offset:43008
  ds_write_b128 v23, v[40:43] offset:43072
  ds_write_b128 v23, v[44:47] offset:43136
  ds_write_b128 v23, v[48:51] offset:43200
  ds_write_b128 v23, v[52:55] offset:43264
  s_waitcnt vmcnt(11)
  v_mfma_f32_16x16x32_bf16 v[160:163], a[40:43], v[216:219], v[160:163]
  v_mfma_f32_16x16x32_bf16 v[164:167], a[44:47], v[216:219], v[164:167]
  v_mfma_f32_16x16x32_bf16 v[168:171], a[48:51], v[216:219], v[168:171]
  v_mfma_f32_16x16x32_bf16 v[172:175], a[52:55], v[216:219], v[172:175]
  v_mfma_f32_16x16x32_bf16 v[176:179], a[56:59], v[216:219], v[176:179]
  s_waitcnt vmcnt(10)
  v_mfma_f32_16x16x32_bf16 v[160:163], a[60:63], v[220:223], v[160:163]
  v_mfma_f32_16x16x32_bf16 v[164:167], a[64:67], v[220:223], v[164:167]
  v_mfma_f32_16x16x32_bf16 v[168:171], a[68:71], v[220:223], v[168:171]
  v_mfma_f32_16x16x32_bf16 v[172:175], a[72:75], v[220:223], v[172:175]
  v_mfma_f32_16x16x32_bf16 v[176:179], a[76:79], v[220:223], v[176:179]
  s_waitcnt vmcnt(9)
  v_mfma_f32_16x16x32_bf16 v[160:163], a[80:83], v[224:227], v[160:163]
  v_mfma_f32_16x16x32_bf16 v[164:167], a[84:87], v[224:227], v[164:167]
  v_mfma_f32_16x16x32_bf16 v[168:171], a[88:91], v[224:227], v[168:171]
  v_mfma_f32_16x16x32_bf16 v[172:175], a[92:95], v[224:227], v[172:175]
  v_mfma_f32_16x16x32_bf16 v[176:179], a[96:99], v[224:227], v[176:179]
  s_waitcnt vmcnt(8)
  v_mfma_f32_16x16x32_bf16 v[160:163], a[100:103], v[228:231], v[160:163]
  v_mfma_f32_16x16x32_bf16 v[164:167], a[104:107], v[228:231], v[164:167]
  v_mfma_f32_16x16x32_bf16 v[168:171], a[108:111], v[228:231], v[168:171]
  v_mfma_f32_16x16x32_bf16 v[172:175], a[112:115], v[228:231], v[172:175]
  v_mfma_f32_16x16x32_bf16 v[176:179], a[116:119], v[228:231], v[176:179]
  s_waitcnt vmcnt(7)
  v_mfma_f32_16x16x32_bf16 v[160:163], a[120:123], v[232:235], v[160:163]
  v_mfma_f32_16x16x32_bf16 v[164:167], a[124:127], v[232:235], v[164:167]
  v_mfma_f32_16x16x32_bf16 v[168:171], a[128:131], v[232:235], v[168:171]
  v_mfma_f32_16x16x32_bf16 v[172:175], a[132:135], v[232:235], v[172:175]
  v_mfma_f32_16x16x32_bf16 v[176:179], a[136:139], v[232:235], v[176:179]
  s_waitcnt vmcnt(6)
  v_mfma_f32_16x16x32_bf16 v[160:163], a[140:143], v[236:239], v[160:163]
  v_mfma_f32_16x16x32_bf16 v[164:167], a[144:147], v[236:239], v[164:167]
  v_mfma_f32_16x16x32_bf16 v[168:171], a[148:151], v[236:239], v[168:171]
  v_mfma_f32_16x16x32_bf16 v[172:175], a[152:155], v[236:239], v[172:175]
  v_mfma_f32_16x16x32_bf16 v[176:179], a[156:159], v[236:239], v[176:179]
  s_waitcnt vmcnt(5)
  v_mfma_f32_16x16x32_bf16 v[160:163], a[160:163], v[240:243], v[160:163]
  v_mfma_f32_16x16x32_bf16 v[164:167], a[164:167], v[240:243], v[164:167]
  v_mfma_f32_16x16x32_bf16 v[168:171], a[168:171], v[240:243], v[168:171]
  v_mfma_f32_16x16x32_bf16 v[172:175], a[172:175], v[240:243], v[172:175]
  v_mfma_f32_16x16x32_bf16 v[176:179], a[176:179], v[240:243], v[176:179]
  s_waitcnt vmcnt(4)
  v_mfma_f32_16x16x32_bf16 v[160:163], a[180:183], v[244:247], v[160:163]
  v_mfma_f32_16x16x32_bf16 v[164:167], a[184:187], v[244:247], v[164:167]
  v_mfma_f32_16x16x32_bf16 v[168:171], a[188:191], v[244:247], v[168:171]
  v_mfma_f32_16x16x32_bf16 v[172:175], a[192:195], v[244:247], v[172:175]
  v_mfma_f32_16x16x32_bf16 v[176:179], a[196:199], v[244:247], v[176:179]
  s_waitcnt vmcnt(3)
  v_mfma_f32_16x16x32_bf16 v[160:163], a[200:203], v[248:251], v[160:163]
  v_mfma_f32_16x16x32_bf16 v[164:167], a[204:207], v[248:251], v[164:167]
  v_mfma_f32_16x16x32_bf16 v[168:171], a[208:211], v[248:251], v[168:171]
  v_mfma_f32_16x16x32_bf16 v[172:175], a[212:215], v[248:251], v[172:175]
  v_mfma_f32_16x16x32_bf16 v[176:179], a[216:219], v[248:251], v[176:179]
  s_waitcnt vmcnt(2)
  v_mfma_f32_16x16x32_bf16 v[160:163], a[220:223], v[252:255], v[160:163]
  v_mfma_f32_16x16x32_bf16 v[164:167], a[224:227], v[252:255], v[164:167]
  v_mfma_f32_16x16x32_bf16 v[168:171], a[228:231], v[252:255], v[168:171]
  v_mfma_f32_16x16x32_bf16 v[172:175], a[232:235], v[252:255], v[172:175]
  v_mfma_f32_16x16x32_bf16 v[176:179], a[236:239], v[252:255], v[176:179]
  s_nop 3
  ds_write_b128 v23, v[160:163] offset:64512
  ds_write_b128 v23, v[164:167] offset:64576
  ds_write_b128 v23, v[168:171] offset:64640
  ds_write_b128 v23, v[172:175] offset:64704
  ds_write_b128 v23, v[176:179] offset:64768
  s_waitcnt lgkmcnt(0)
  s_barrier
  ds_read_b128 v[64:67], v2 offset:0
  ds_read_b128 v[68:71], v2 offset:16
  ds_read_b128 v[72:75], v2 offset:5376
  ds_read_b128 v[76:79], v2 offset:5392
  ds_read_b128 v[80:83], v2 offset:10752
  ds_read_b128 v[84:87], v2 offset:10768
  ds_read_b128 v[88:91], v2 offset:16128
  ds_read_b128 v[92:95], v2 offset:16144
  ds_read_b128 v[96:99], v3 offset:0
  ds_read_b128 v[100:103], v3 offset:16
  ds_read_b128 v[104:107], v3 offset:5376
  ds_read_b128 v[108:111], v3 offset:5392
  ds_read_b128 v[112:115], v3 offset:10752
  ds_read_b128 v[116:119], v3 offset:10768
  ds_read_b128 v[120:123], v3 offset:16128
  s_waitcnt lgkmcnt(14)
  ds_read_b128 v[124:127], v3 offset:16144
  s_waitcnt lgkmcnt(14)
  ds_read_b128 v[128:131], v4 offset:0
  s_waitcnt lgkmcnt(14)
  ds_read_b128 v[132:135], v4 offset:16
  s_waitcnt lgkmcnt(14)
  ds_read_b128 v[136:139], v4 offset:5376
  s_waitcnt lgkmcnt(14)
  ds_read_b128 v[140:143], v4 offset:5392
  s_waitcnt lgkmcnt(14)
  ds_read_b128 v[144:147], v4 offset:10752
  s_waitcnt lgkmcnt(14)
  ds_read_b128 v[148:151], v4 offset:10768
  s_waitcnt lgkmcnt(14)
  ds_read_b128 v[152:155], v4 offset:16128
  s_waitcnt lgkmcnt(14)
  ds_read_b128 v[156:159], v4 offset:16144
  v_pk_add_f32 v[64:65], v[64:65], v[72:73]
  v_pk_add_f32 v[66:67], v[66:67], v[74:75]
  v_pk_add_f32 v[68:69], v[68:69], v[76:77]
  v_pk_add_f32 v[70:71], v[70:71], v[78:79]
  v_pk_add_f32 v[80:81], v[80:81], v[88:89]
  v_pk_add_f32 v[82:83], v[82:83], v[90:91]
  v_pk_add_f32 v[84:85], v[84:85], v[92:93]
  v_pk_add_f32 v[86:87], v[86:87], v[94:95]
  v_pk_add_f32 v[64:65], v[64:65], v[80:81]
  v_pk_add_f32 v[66:67], v[66:67], v[82:83]
  v_pk_add_f32 v[68:69], v[68:69], v[84:85]
  v_pk_add_f32 v[70:71], v[70:71], v[86:87]
  v_cvt_pk_bf16_f32 v72, v64, v65
  v_cvt_pk_bf16_f32 v73, v66, v67
  v_cvt_pk_bf16_f32 v74, v68, v69
  v_cvt_pk_bf16_f32 v75, v70, v71
  v_lshlrev_b32 v64, 16, v72
  v_and_b32 v65, 0xffff0000, v72
  v_lshlrev_b32 v80, 16, v24
  v_and_b32 v81, 0xffff0000, v24
  v_lshlrev_b32 v66, 16, v73
  v_and_b32 v67, 0xffff0000, v73
  v_lshlrev_b32 v82, 16, v25
  v_and_b32 v83, 0xffff0000, v25
  v_lshlrev_b32 v68, 16, v74
  v_and_b32 v69, 0xffff0000, v74
  v_lshlrev_b32 v84, 16, v26
  v_and_b32 v85, 0xffff0000, v26
  v_lshlrev_b32 v70, 16, v75
  v_and_b32 v71, 0xffff0000, v75
  v_lshlrev_b32 v86, 16, v27
  v_and_b32 v87, 0xffff0000, v27
  v_pk_add_f32 v[64:65], v[64:65], v[80:81]
  v_pk_add_f32 v[66:67], v[66:67], v[82:83]
  v_pk_add_f32 v[68:69], v[68:69], v[84:85]
  v_pk_add_f32 v[70:71], v[70:71], v[86:87]
  v_cvt_pk_bf16_f32 v72, v64, v65
  v_cvt_pk_bf16_f32 v73, v66, v67
  v_cvt_pk_bf16_f32 v74, v68, v69
  v_cvt_pk_bf16_f32 v75, v70, v71
  buffer_store_dwordx4 v[72:75], v7, s[40:43], 0 offen
  s_waitcnt lgkmcnt(8)
  v_pk_add_f32 v[96:97], v[96:97], v[104:105]
  v_pk_add_f32 v[98:99], v[98:99], v[106:107]
  v_pk_add_f32 v[100:101], v[100:101], v[108:109]
  v_pk_add_f32 v[102:103], v[102:103], v[110:111]
  v_pk_add_f32 v[112:113], v[112:113], v[120:121]
  v_pk_add_f32 v[114:115], v[114:115], v[122:123]
  v_pk_add_f32 v[116:117], v[116:117], v[124:125]
  v_pk_add_f32 v[118:119], v[118:119], v[126:127]
  v_pk_add_f32 v[96:97], v[96:97], v[112:113]
  v_pk_add_f32 v[98:99], v[98:99], v[114:115]
  v_pk_add_f32 v[100:101], v[100:101], v[116:117]
  v_pk_add_f32 v[102:103], v[102:103], v[118:119]
  v_cvt_pk_bf16_f32 v104, v96, v97
  v_cvt_pk_bf16_f32 v105, v98, v99
  v_cvt_pk_bf16_f32 v106, v100, v101
  v_cvt_pk_bf16_f32 v107, v102, v103
  v_lshlrev_b32 v96, 16, v104
  v_and_b32 v97, 0xffff0000, v104
  v_lshlrev_b32 v112, 16, v28
  v_and_b32 v113, 0xffff0000, v28
  v_lshlrev_b32 v98, 16, v105
  v_and_b32 v99, 0xffff0000, v105
  v_lshlrev_b32 v114, 16, v29
  v_and_b32 v115, 0xffff0000, v29
  v_lshlrev_b32 v100, 16, v106
  v_and_b32 v101, 0xffff0000, v106
  v_lshlrev_b32 v116, 16, v30
  v_and_b32 v117, 0xffff0000, v30
  v_lshlrev_b32 v102, 16, v107
  v_and_b32 v103, 0xffff0000, v107
  v_lshlrev_b32 v118, 16, v31
  v_and_b32 v119, 0xffff0000, v31
  v_pk_add_f32 v[96:97], v[96:97], v[112:113]
  v_pk_add_f32 v[98:99], v[98:99], v[114:115]
  v_pk_add_f32 v[100:101], v[100:101], v[116:117]
  v_pk_add_f32 v[102:103], v[102:103], v[118:119]
  v_cvt_pk_bf16_f32 v104, v96, v97
  v_cvt_pk_bf16_f32 v105, v98, v99
  v_cvt_pk_bf16_f32 v106, v100, v101
  v_cvt_pk_bf16_f32 v107, v102, v103
  buffer_store_dwordx4 v[104:107], v8, s[40:43], 0 offen
  s_waitcnt lgkmcnt(0)
  v_pk_add_f32 v[128:129], v[128:129], v[136:137]
  v_pk_add_f32 v[130:131], v[130:131], v[138:139]
  v_pk_add_f32 v[132:133], v[132:133], v[140:141]
  v_pk_add_f32 v[134:135], v[134:135], v[142:143]
  v_pk_add_f32 v[144:145], v[144:145], v[152:153]
  v_pk_add_f32 v[146:147], v[146:147], v[154:155]
  v_pk_add_f32 v[148:149], v[148:149], v[156:157]
  v_pk_add_f32 v[150:151], v[150:151], v[158:159]
  v_pk_add_f32 v[128:129], v[128:129], v[144:145]
  v_pk_add_f32 v[130:131], v[130:131], v[146:147]
  v_pk_add_f32 v[132:133], v[132:133], v[148:149]
  v_pk_add_f32 v[134:135], v[134:135], v[150:151]
  v_cvt_pk_bf16_f32 v136, v128, v129
  v_cvt_pk_bf16_f32 v137, v130, v131
  v_cvt_pk_bf16_f32 v138, v132, v133
  v_cvt_pk_bf16_f32 v139, v134, v135
  v_lshlrev_b32 v128, 16, v136
  v_and_b32 v129, 0xffff0000, v136
  v_lshlrev_b32 v144, 16, v32
  v_and_b32 v145, 0xffff0000, v32
  v_lshlrev_b32 v130, 16, v137
  v_and_b32 v131, 0xffff0000, v137
  v_lshlrev_b32 v146, 16, v33
  v_and_b32 v147, 0xffff0000, v33
  v_lshlrev_b32 v132, 16, v138
  v_and_b32 v133, 0xffff0000, v138
  v_lshlrev_b32 v148, 16, v34
  v_and_b32 v149, 0xffff0000, v34
  v_lshlrev_b32 v134, 16, v139
  v_and_b32 v135, 0xffff0000, v139
  v_lshlrev_b32 v150, 16, v35
  v_and_b32 v151, 0xffff0000, v35
  v_pk_add_f32 v[128:129], v[128:129], v[144:145]
  v_pk_add_f32 v[130:131], v[130:131], v[146:147]
  v_pk_add_f32 v[132:133], v[132:133], v[148:149]
  v_pk_add_f32 v[134:135], v[134:135], v[150:151]
  v_cvt_pk_bf16_f32 v136, v128, v129
  v_cvt_pk_bf16_f32 v137, v130, v131
  v_cvt_pk_bf16_f32 v138, v132, v133
  v_cvt_pk_bf16_f32 v139, v134, v135
  buffer_store_dwordx4 v[136:139], v9, s[40:43], 0 offen
  s_waitcnt vmcnt(3)
  s_cmp_lg_u32 s53, 3
  s_cbranch_scc1 L_nogen
L_chkg:
  v_cmp_ne_u32 vcc, s44, v14
  v_cmp_ne_u32 s[46:47], s45, v15
  s_nop 1
  s_or_b64 vcc, vcc, s[46:47]
  v_cmp_ne_u32 s[46:47], s44, v16
  s_nop 1
  s_or_b64 vcc, vcc, s[46:47]
  v_cmp_ne_u32 s[46:47], s45, v17
  s_nop 1
  s_or_b64 vcc, vcc, s[46:47]
  v_cmp_ne_u32 s[46:47], s44, v18
  s_nop 1
  s_or_b64 vcc, vcc, s[46:47]
  v_cmp_ne_u32 s[46:47], s45, v19
  s_nop 1
  s_or_b64 vcc, vcc, s[46:47]
  v_cmp_ne_u32 s[46:47], s44, v20
  s_nop 1
  s_or_b64 vcc, vcc, s[46:47]
  v_cmp_ne_u32 s[46:47], s45, v21
  s_nop 1
  s_or_b64 vcc, vcc, s[46:47]
  s_cbranch_scc0 L_okg
  s_add_u32 s20, s20, 1
  s_cmp_gt_u32 s20, 0x40000
  s_cbranch_scc1 L_okg
  s_sleep 2
  buffer_load_dwordx4 v[14:17], v13, s[36:39], 0 offen sc1
  buffer_load_dwordx4 v[18:21], v13, s[36:39], 0 offen offset:1024 sc1
  s_waitcnt vmcnt(0)
  s_branch L_chkg
L_okg:
  v_mov_b32 v14, 8519680
  v_mov_b32 v15, 2147418112
  v_mov_b32 v16, s44
  v_mov_b32 v17, s45
  v_cmp_eq_u32 vcc, 0, v0
  s_nop 1
  v_cndmask_b32 v14, v15, v14, vcc
  buffer_store_dwordx2 v[16:17], v14, s[36:39], 0 offen sc1
L_nogen:
L_end:
  s_endpgm
L_codeend:
.fill 512, 4, 0xbf800000
.section .rodata,"a"
.p2align 6
.amdhsa_kernel standalone__mixer_channel_mlp__prompt_kernel
  .amdhsa_next_free_vgpr 512
  .amdhsa_next_free_sgpr 102
  .amdhsa_accum_offset 256
  .amdhsa_group_segment_fixed_size 0
  .amdhsa_kernarg_size 64
  .amdhsa_user_sgpr_count 2
  .amdhsa_user_sgpr_kernarg_segment_ptr 1
  .amdhsa_system_sgpr_workgroup_id_x 1
.end_amdhsa_kernel
```
